```python
import torch

def _softmax(x, axis=-1):
    return torch.softmax(x, dim=axis)
def _gelu(x):
    return torch.nn.functional.gelu(x, approximate="tanh")
def _silu(x):
    return torch.nn.functional.silu(x)
def _sigmoid(x):
    return torch.sigmoid(x)
def _layernorm(x, axis=-1, eps=1e-5):
    m = x.mean(dim=axis, keepdim=True)
    v = x.var(dim=axis, keepdim=True, unbiased=False)
    return (x - m) / torch.sqrt(v + eps)
def _scatter_add(tgt, idx, src, axis=0):
    return tgt.clone().index_add_(axis, idx, src)
def _segment_sum(src, seg, n):
    out = torch.zeros((n,) + src.shape[1:], dtype=src.dtype)
    return out.index_add_(0, seg, src)
def _pad(x, pw):
    flat = tuple(v for pair in reversed(pw) for v in pair)
    return torch.nn.functional.pad(x, flat)

kernel_name = 'recurrent_scan__mha_block_cached__swiglu_ffn__decode'

def setup_inputs():

    _w = (lambda a: (lambda t: t.to(torch.bfloat16) if t.is_floating_point() else t)(torch.as_tensor(a)))
    def _A_setup():
        B, Sq, D = 4, 1, 512
        H, Sk, Dh = 32, 8192, 128
        return {
            "x": _w((lambda *s: torch.randn(*s, dtype=torch.bfloat16) * 0.05)(B, Sq, D)),
            "k_cache": _w((lambda *s: torch.randn(*s, dtype=torch.bfloat16) * 1.6)(B, H, Sk, Dh)),
            "v_cache": _w((lambda *s: torch.randn(*s, dtype=torch.bfloat16) * 0.2)(B, H, Sk, Dh)),
            "wq": _w((lambda *s: torch.randn(*s, dtype=torch.bfloat16) * 1.6)(D, H * Dh) * (D ** -0.5)),
            "wo": _w((lambda *s: torch.randn(*s, dtype=torch.bfloat16) * 0.2)(H * Dh, D) * ((H * Dh) ** -0.5)),
        }
    _A_in = _A_setup()

    def _B_setup():
        B, S, D, F = 4, 1, 512, 1792
        return {
            "x": _w((lambda *s: torch.randn(*s, dtype=torch.bfloat16) * 0.05)(B, S, D)),
            "w_gate": _w((lambda *s: torch.randn(*s, dtype=torch.bfloat16) * 0.1)(D, F)),
            "w_up": _w((lambda *s: torch.randn(*s, dtype=torch.bfloat16) * 0.1)(D, F)),
            "w_down": _w((lambda *s: torch.randn(*s, dtype=torch.bfloat16) * 0.1)(F, D)),
        }
    _B_in = _B_setup()

    return {
        "A_x": _A_in["x"],
        "A_k_cache": _A_in["k_cache"],
        "A_v_cache": _A_in["v_cache"],
        "A_wq": _A_in["wq"],
        "A_wo": _A_in["wo"],
        "B_x": _B_in["x"],
        "B_w_gate": _B_in["w_gate"],
        "B_w_up": _B_in["w_up"],
        "B_w_down": _B_in["w_down"],
    }

def reference(A_x, A_k_cache, A_v_cache, A_wq, A_wo, B_x, B_w_gate, B_w_up, B_w_down):
    def _A_ref(x, k_cache, v_cache, wq, wo):
        B, Sq, D = x.shape
        H, Dh = 32, 128
        q = (lambda x, *d: x.permute(*d))((x @ wq).reshape(B, Sq, H, Dh), 0, 2, 1, 3)
        scores = torch.einsum("bhqd,bhkd->bhqk", q, k_cache) * (Dh ** -0.5)
        p = _softmax(scores, axis=-1)
        o = torch.einsum("bhqk,bhkd->bhqd", p, v_cache)
        return (lambda x, *d: x.permute(*d))(o, 0, 2, 1, 3).reshape(B, Sq, H * Dh) @ wo

    def _B_ref(x, w_gate, w_up, w_down):
        g = _silu(x @ w_gate)
        u = x @ w_up
        return (g * u) @ w_down

    x = A_x
    xn = _layernorm(x, axis=-1)
    s = _A_ref(xn, A_k_cache, A_v_cache, A_wq, A_wo)
    g = _silu(_B_ref(xn, B_w_gate, B_w_up, B_w_down))
    return x + s * g
```

```asm
; @launch grid=(256,1,1) block=(384,1,1) lds=163840
  .amdgcn_target "amdgcn-amd-amdhsa--gfx950"
  .text
  .globl recurrent_scan__mha_block_cached__swiglu_ffn__decode_kernel
  .p2align 8
  .type recurrent_scan__mha_block_cached__swiglu_ffn__decode_kernel,@function
recurrent_scan__mha_block_cached__swiglu_ffn__decode_kernel:
  s_cmp_ge_u32 s2, 256
  s_cbranch_scc1 L_exit
  v_lshrrev_b32 v1, 6, v0
  v_and_b32 v0, 63, v0
  v_readfirstlane_b32 s3, v1
  s_cmp_lg_u32 s3, 1
  s_cbranch_scc1 L_p1
  v_and_b32 v1, 7, v0
  v_lshlrev_b32 v1, 8, v1
  v_add_u32 v1, 131072, v1
  v_mov_b32 v2, 0
  v_mov_b32 v3, 0
  ds_write_b64 v1, v[2:3]
  s_waitcnt lgkmcnt(0)
L_p1:
  s_load_dwordx16 s[4:19], s[0:1], 0
  s_load_dwordx8 s[20:27], s[0:1], 64
  s_barrier
  v_lshrrev_b32 v2, 4, v0
  v_and_b32 v3, 15, v0
  s_and_b32 s28, s2, 7
  s_lshr_b32 s29, s2, 3
  s_and_b32 s30, s29, 1
  s_bfe_u32 s31, s29, 0x20001
  s_lshl_b32 s31, s31, 3
  s_or_b32 s31, s31, s28
  s_lshr_b32 s32, s29, 3
  s_lshl1_add_u32 s33, s31, s30
  s_lshl_b32 s29, s32, 6
  s_add_u32 s33, s33, s29
  s_mov_b32 s34, 1048576
  s_cmp_eq_u32 s3, 1
  s_cbranch_scc1 L_side
  s_cmp_gt_u32 s3, 1
  s_cbranch_scc1 L_main
  s_setprio 3
  v_add_u32 v4, 0, v2
  v_xor_b32 v4, v4, v3
  v_lshlrev_b32 v4, 4, v4
  v_lshl_add_u32 v4, v2, 8, v4
  v_add_u32 v5, 4, v2
  v_xor_b32 v5, v5, v3
  v_lshlrev_b32 v5, 4, v5
  v_lshl_add_u32 v5, v2, 8, v5
  v_add_u32 v6, 8, v2
  v_xor_b32 v6, v6, v3
  v_lshlrev_b32 v6, 4, v6
  v_lshl_add_u32 v6, v2, 8, v6
  v_add_u32 v7, 12, v2
  v_xor_b32 v7, v7, v3
  v_lshlrev_b32 v7, 4, v7
  v_lshl_add_u32 v7, v2, 8, v7
  v_lshlrev_b32 v8, 4, v0
  v_lshlrev_b32 v9, 2, v0
  v_add_u32 v9, 131072, v9
  v_lshlrev_b32 v10, 8, v0
  v_add_u32 v10, 131328, v10
  v_mov_b32 v11, 132868
  v_cmp_gt_u32 vcc, 4, v0
  s_nop 1
  v_cndmask_b32 v10, v11, v10, vcc
  v_mov_b32 v11, 0
  s_lshr_b32 s44, s33, 1
  s_lshl_b32 s44, s44, 21
  s_lshl_b32 s45, s30, 15
  v_add_u32 v4, s45, v4
  v_add_u32 v5, s45, v5
  v_add_u32 v6, s45, v6
  v_add_u32 v7, s45, v7
  v_add_u32 v8, s45, v8
  s_mov_b32 s45, 0
  s_mov_b32 s46, 0
  s_mov_b32 s47, s44
  s_mov_b32 s38, 0x10000000
  s_mov_b32 s39, 0x20000
  s_mov_b32 s51, 0
  s_waitcnt lgkmcnt(0)
  s_mov_b32 s36, s6
  s_mov_b32 s37, s7
  s_cmp_lt_u32 s2, 14
  s_cselect_b32 s56, 24, 20
  s_mov_b32 s54, 27
L_w27:
  s_mov_b32 m0, s46
  s_waitcnt vmcnt(26)
  buffer_load_dwordx4 v4, s[36:39], s47 offen offset:0 nt lds
  s_waitcnt vmcnt(26)
  buffer_load_dwordx4 v5, s[36:39], s47 offen offset:1024 nt lds
  s_waitcnt vmcnt(26)
  buffer_load_dwordx4 v6, s[36:39], s47 offen offset:2048 nt lds
  s_waitcnt vmcnt(26)
  buffer_load_dwordx4 v7, s[36:39], s47 offen offset:3072 nt lds
  s_add_u32 s47, s47, 0x1000
  s_add_u32 s46, s46, 0x1000
  s_mov_b32 m0, s46
  s_waitcnt vmcnt(26)
  buffer_load_dwordx4 v4, s[36:39], s47 offen offset:0 nt lds
  s_waitcnt vmcnt(26)
  buffer_load_dwordx4 v5, s[36:39], s47 offen offset:1024 nt lds
  ds_read_b32 v11, v10
  s_waitcnt vmcnt(26)
  buffer_load_dwordx4 v6, s[36:39], s47 offen offset:2048 nt lds
  s_waitcnt vmcnt(26)
  buffer_load_dwordx4 v7, s[36:39], s47 offen offset:3072 nt lds
  s_add_u32 s47, s47, 0x1000
  s_add_u32 s46, s46, 0x1000
  s_mov_b32 m0, s46
  s_waitcnt vmcnt(26)
  buffer_load_dwordx4 v4, s[36:39], s47 offen offset:0 nt lds
  s_waitcnt vmcnt(26)
  buffer_load_dwordx4 v5, s[36:39], s47 offen offset:1024 nt lds
  s_add_u32 s55, s45, 1
  s_and_b32 s48, s55, 3
  s_sub_i32 s50, s55, 4
  s_ashr_i32 s50, s50, 2
  s_cmp_ge_u32 s55, 10
  s_cselect_b32 s54, s56, s54
  s_waitcnt vmcnt(26)
  buffer_load_dwordx4 v6, s[36:39], s47 offen offset:2048 nt lds
  s_sub_i32 s52, s45, 1
  s_max_i32 s51, s51, s52
  v_mov_b32 v12, s51
  ds_write_b32 v9, v12
  s_waitcnt vmcnt(26)
  buffer_load_dwordx4 v7, s[36:39], s47 offen offset:3072 nt lds
  s_add_u32 s47, s47, 0x1000
  s_add_u32 s46, s46, 0x1000
  s_mov_b32 m0, s46
  s_waitcnt vmcnt(26)
  buffer_load_dwordx4 v4, s[36:39], s47 offen offset:0 nt lds
  s_waitcnt lgkmcnt(0)
  v_readlane_b32 s49, v11, s48
  v_readlane_b32 s53, v11, 4
  s_and_b32 s55, s55, 63
  s_waitcnt vmcnt(26)
  buffer_load_dwordx4 v5, s[36:39], s47 offen offset:1024 nt lds
  s_cmp_eq_u32 s53, 0
  s_cselect_b32 s53, s54, s53
  s_cmp_ge_u32 s45, 123
  s_cselect_b32 s53, 44, s53
  s_cmp_eq_u32 s53, 27
  s_cselect_b32 s55, s55, 0
  s_cmp_ge_i32 s49, s50
  s_cselect_b32 s55, s55, 0
  s_waitcnt vmcnt(26)
  buffer_load_dwordx4 v6, s[36:39], s47 offen offset:2048 nt lds
  s_waitcnt vmcnt(26)
  buffer_load_dwordx4 v7, s[36:39], s47 offen offset:3072 nt lds
  s_or_b32 s47, s47, 32768
  s_add_u32 s47, s47, 0x1000
  s_andn2_b32 s47, s47, 32768
  s_add_u32 s46, s46, 0x1000
  s_and_b32 s46, s46, 0x1ffff
  s_add_u32 s45, s45, 1
  s_cmp_lg_u32 s55, 0
  s_cbranch_scc1 L_w27
  s_branch L_slow
L_w20:
  s_mov_b32 m0, s46
  s_waitcnt vmcnt(19)
  buffer_load_dwordx4 v4, s[36:39], s47 offen offset:0 nt lds
  s_waitcnt vmcnt(19)
  buffer_load_dwordx4 v5, s[36:39], s47 offen offset:1024 nt lds
  s_waitcnt vmcnt(19)
  buffer_load_dwordx4 v6, s[36:39], s47 offen offset:2048 nt lds
  s_waitcnt vmcnt(19)
  buffer_load_dwordx4 v7, s[36:39], s47 offen offset:3072 nt lds
  s_sub_i32 s52, s45, 1
  s_max_i32 s51, s51, s52
  v_mov_b32 v12, s51
  ds_write_b32 v9, v12
  s_add_u32 s47, s47, 0x1000
  s_add_u32 s46, s46, 0x1000
  s_mov_b32 m0, s46
  s_waitcnt vmcnt(19)
  buffer_load_dwordx4 v4, s[36:39], s47 offen offset:0 nt lds
  s_waitcnt vmcnt(19)
  buffer_load_dwordx4 v5, s[36:39], s47 offen offset:1024 nt lds
  ds_read_b32 v11, v10
  s_waitcnt vmcnt(19)
  buffer_load_dwordx4 v6, s[36:39], s47 offen offset:2048 nt lds
  s_waitcnt vmcnt(19)
  buffer_load_dwordx4 v7, s[36:39], s47 offen offset:3072 nt lds
  s_add_u32 s47, s47, 0x1000
  s_add_u32 s46, s46, 0x1000
  s_mov_b32 m0, s46
  s_waitcnt vmcnt(19)
  buffer_load_dwordx4 v4, s[36:39], s47 offen offset:0 nt lds
  s_waitcnt vmcnt(19)
  buffer_load_dwordx4 v5, s[36:39], s47 offen offset:1024 nt lds
  s_add_u32 s55, s45, 1
  s_and_b32 s48, s55, 3
  s_sub_i32 s50, s55, 4
  s_ashr_i32 s50, s50, 2
  s_waitcnt vmcnt(19)
  buffer_load_dwordx4 v6, s[36:39], s47 offen offset:2048 nt lds
  s_waitcnt vmcnt(19)
  buffer_load_dwordx4 v7, s[36:39], s47 offen offset:3072 nt lds
  s_add_u32 s47, s47, 0x1000
  s_add_u32 s46, s46, 0x1000
  s_mov_b32 m0, s46
  s_waitcnt vmcnt(19)
  buffer_load_dwordx4 v4, s[36:39], s47 offen offset:0 nt lds
  s_waitcnt lgkmcnt(0)
  v_readlane_b32 s49, v11, s48
  v_readlane_b32 s53, v11, 4
  s_and_b32 s55, s55, 63
  s_waitcnt vmcnt(19)
  buffer_load_dwordx4 v5, s[36:39], s47 offen offset:1024 nt lds
  s_cmp_eq_u32 s53, 0
  s_cselect_b32 s53, s54, s53
  s_cmp_ge_u32 s45, 123
  s_cselect_b32 s53, 44, s53
  s_cmp_eq_u32 s53, 20
  s_cselect_b32 s55, s55, 0
  s_cmp_ge_i32 s49, s50
  s_cselect_b32 s55, s55, 0
  s_waitcnt vmcnt(19)
  buffer_load_dwordx4 v6, s[36:39], s47 offen offset:2048 nt lds
  s_waitcnt vmcnt(19)
  buffer_load_dwordx4 v7, s[36:39], s47 offen offset:3072 nt lds
  s_or_b32 s47, s47, 32768
  s_add_u32 s47, s47, 0x1000
  s_andn2_b32 s47, s47, 32768
  s_add_u32 s46, s46, 0x1000
  s_and_b32 s46, s46, 0x1ffff
  s_add_u32 s45, s45, 1
  s_cmp_lg_u32 s55, 0
  s_cbranch_scc1 L_w20
L_slow:
  s_and_b32 s52, s45, 63
  s_cbranch_scc1 L_ldspin
  s_cmp_ge_u32 s45, 128
  s_cbranch_scc1 L_drain
  s_mov_b32 s36, s8
  s_mov_b32 s37, s9
  s_mov_b32 s47, s44
  v_mov_b32 v4, v8
  v_mov_b32 v5, v8
  v_mov_b32 v6, v8
  v_mov_b32 v7, v8
L_ldspin:
  s_cmp_ge_i32 s49, s50
  s_cbranch_scc1 L_ldsel
  s_sleep 1
  ds_read_b32 v11, v10
  s_waitcnt lgkmcnt(0)
  v_readlane_b32 s49, v11, s48
  s_sub_u32 s34, s34, 1
  s_cbranch_scc1 L_exit
  s_branch L_ldspin
L_ldsel:
  s_cmp_eq_u32 s53, 17
  s_cbranch_scc1 L_w17
  s_cmp_eq_u32 s53, 18
  s_cbranch_scc1 L_w18
  s_cmp_eq_u32 s53, 19
  s_cbranch_scc1 L_w19
  s_cmp_eq_u32 s53, 22
  s_cbranch_scc1 L_w22
  s_cmp_eq_u32 s53, 24
  s_cbranch_scc1 L_w24
  s_cmp_eq_u32 s53, 27
  s_cbranch_scc1 L_w27
  s_cmp_eq_u32 s53, 31
  s_cbranch_scc1 L_w31
  s_cmp_eq_u32 s53, 36
  s_cbranch_scc1 L_w36
  s_cmp_eq_u32 s53, 44
  s_cbranch_scc1 L_w44
  s_branch L_w20
L_drain:
  s_waitcnt vmcnt(48)
  s_max_i32 s51, s51, 125
  v_mov_b32 v12, s51
  ds_write_b32 v9, v12
  s_waitcnt vmcnt(32)
  s_max_i32 s51, s51, 126
  v_mov_b32 v12, s51
  ds_write_b32 v9, v12
  s_waitcnt vmcnt(16)
  s_max_i32 s51, s51, 127
  v_mov_b32 v12, s51
  ds_write_b32 v9, v12
  v_mov_b32 v12, 128
  s_waitcnt vmcnt(12)
  ds_write_b32 v9, v12
  v_mov_b32 v12, 129
  s_waitcnt vmcnt(8)
  ds_write_b32 v9, v12
  v_mov_b32 v12, 130
  s_waitcnt vmcnt(4)
  ds_write_b32 v9, v12
  v_mov_b32 v12, 131
  s_waitcnt vmcnt(0)
  ds_write_b32 v9, v12
  s_waitcnt lgkmcnt(0)
  s_endpgm
L_w17:
  s_mov_b32 m0, s46
  s_waitcnt vmcnt(16)
  buffer_load_dwordx4 v4, s[36:39], s47 offen offset:0 nt lds
  s_sub_i32 s52, s45, 1
  s_max_i32 s51, s51, s52
  v_mov_b32 v12, s51
  ds_write_b32 v9, v12
  s_waitcnt vmcnt(16)
  buffer_load_dwordx4 v5, s[36:39], s47 offen offset:1024 nt lds
  s_waitcnt vmcnt(16)
  buffer_load_dwordx4 v6, s[36:39], s47 offen offset:2048 nt lds
  s_waitcnt vmcnt(16)
  buffer_load_dwordx4 v7, s[36:39], s47 offen offset:3072 nt lds
  s_add_u32 s47, s47, 0x1000
  s_add_u32 s46, s46, 0x1000
  s_mov_b32 m0, s46
  s_waitcnt vmcnt(16)
  buffer_load_dwordx4 v4, s[36:39], s47 offen offset:0 nt lds
  s_waitcnt vmcnt(16)
  buffer_load_dwordx4 v5, s[36:39], s47 offen offset:1024 nt lds
  ds_read_b32 v11, v10
  s_waitcnt vmcnt(16)
  buffer_load_dwordx4 v6, s[36:39], s47 offen offset:2048 nt lds
  s_waitcnt vmcnt(16)
  buffer_load_dwordx4 v7, s[36:39], s47 offen offset:3072 nt lds
  s_add_u32 s47, s47, 0x1000
  s_add_u32 s46, s46, 0x1000
  s_mov_b32 m0, s46
  s_waitcnt vmcnt(16)
  buffer_load_dwordx4 v4, s[36:39], s47 offen offset:0 nt lds
  s_waitcnt vmcnt(16)
  buffer_load_dwordx4 v5, s[36:39], s47 offen offset:1024 nt lds
  s_add_u32 s55, s45, 1
  s_and_b32 s48, s55, 3
  s_sub_i32 s50, s55, 4
  s_ashr_i32 s50, s50, 2
  s_waitcnt vmcnt(16)
  buffer_load_dwordx4 v6, s[36:39], s47 offen offset:2048 nt lds
  s_waitcnt vmcnt(16)
  buffer_load_dwordx4 v7, s[36:39], s47 offen offset:3072 nt lds
  s_add_u32 s47, s47, 0x1000
  s_add_u32 s46, s46, 0x1000
  s_mov_b32 m0, s46
  s_waitcnt vmcnt(16)
  buffer_load_dwordx4 v4, s[36:39], s47 offen offset:0 nt lds
  s_waitcnt lgkmcnt(0)
  v_readlane_b32 s49, v11, s48
  v_readlane_b32 s53, v11, 4
  s_and_b32 s55, s55, 63
  s_waitcnt vmcnt(16)
  buffer_load_dwordx4 v5, s[36:39], s47 offen offset:1024 nt lds
  s_cmp_eq_u32 s53, 0
  s_cselect_b32 s53, s54, s53
  s_cmp_ge_u32 s45, 123
  s_cselect_b32 s53, 44, s53
  s_cmp_eq_u32 s53, 17
  s_cselect_b32 s55, s55, 0
  s_cmp_ge_i32 s49, s50
  s_cselect_b32 s55, s55, 0
  s_waitcnt vmcnt(16)
  buffer_load_dwordx4 v6, s[36:39], s47 offen offset:2048 nt lds
  s_waitcnt vmcnt(16)
  buffer_load_dwordx4 v7, s[36:39], s47 offen offset:3072 nt lds
  s_or_b32 s47, s47, 32768
  s_add_u32 s47, s47, 0x1000
  s_andn2_b32 s47, s47, 32768
  s_add_u32 s46, s46, 0x1000
  s_and_b32 s46, s46, 0x1ffff
  s_add_u32 s45, s45, 1
  s_cmp_lg_u32 s55, 0
  s_cbranch_scc1 L_w17
  s_branch L_slow
L_w18:
  s_mov_b32 m0, s46
  s_waitcnt vmcnt(17)
  buffer_load_dwordx4 v4, s[36:39], s47 offen offset:0 nt lds
  s_waitcnt vmcnt(17)
  buffer_load_dwordx4 v5, s[36:39], s47 offen offset:1024 nt lds
  s_sub_i32 s52, s45, 1
  s_max_i32 s51, s51, s52
  v_mov_b32 v12, s51
  ds_write_b32 v9, v12
  s_waitcnt vmcnt(17)
  buffer_load_dwordx4 v6, s[36:39], s47 offen offset:2048 nt lds
  s_waitcnt vmcnt(17)
  buffer_load_dwordx4 v7, s[36:39], s47 offen offset:3072 nt lds
  s_add_u32 s47, s47, 0x1000
  s_add_u32 s46, s46, 0x1000
  s_mov_b32 m0, s46
  s_waitcnt vmcnt(17)
  buffer_load_dwordx4 v4, s[36:39], s47 offen offset:0 nt lds
  s_waitcnt vmcnt(17)
  buffer_load_dwordx4 v5, s[36:39], s47 offen offset:1024 nt lds
  ds_read_b32 v11, v10
  s_waitcnt vmcnt(17)
  buffer_load_dwordx4 v6, s[36:39], s47 offen offset:2048 nt lds
  s_waitcnt vmcnt(17)
  buffer_load_dwordx4 v7, s[36:39], s47 offen offset:3072 nt lds
  s_add_u32 s47, s47, 0x1000
  s_add_u32 s46, s46, 0x1000
  s_mov_b32 m0, s46
  s_waitcnt vmcnt(17)
  buffer_load_dwordx4 v4, s[36:39], s47 offen offset:0 nt lds
  s_waitcnt vmcnt(17)
  buffer_load_dwordx4 v5, s[36:39], s47 offen offset:1024 nt lds
  s_add_u32 s55, s45, 1
  s_and_b32 s48, s55, 3
  s_sub_i32 s50, s55, 4
  s_ashr_i32 s50, s50, 2
  s_waitcnt vmcnt(17)
  buffer_load_dwordx4 v6, s[36:39], s47 offen offset:2048 nt lds
  s_waitcnt vmcnt(17)
  buffer_load_dwordx4 v7, s[36:39], s47 offen offset:3072 nt lds
  s_add_u32 s47, s47, 0x1000
  s_add_u32 s46, s46, 0x1000
  s_mov_b32 m0, s46
  s_waitcnt vmcnt(17)
  buffer_load_dwordx4 v4, s[36:39], s47 offen offset:0 nt lds
  s_waitcnt lgkmcnt(0)
  v_readlane_b32 s49, v11, s48
  v_readlane_b32 s53, v11, 4
  s_and_b32 s55, s55, 63
  s_waitcnt vmcnt(17)
  buffer_load_dwordx4 v5, s[36:39], s47 offen offset:1024 nt lds
  s_cmp_eq_u32 s53, 0
  s_cselect_b32 s53, s54, s53
  s_cmp_ge_u32 s45, 123
  s_cselect_b32 s53, 44, s53
  s_cmp_eq_u32 s53, 18
  s_cselect_b32 s55, s55, 0
  s_cmp_ge_i32 s49, s50
  s_cselect_b32 s55, s55, 0
  s_waitcnt vmcnt(17)
  buffer_load_dwordx4 v6, s[36:39], s47 offen offset:2048 nt lds
  s_waitcnt vmcnt(17)
  buffer_load_dwordx4 v7, s[36:39], s47 offen offset:3072 nt lds
  s_or_b32 s47, s47, 32768
  s_add_u32 s47, s47, 0x1000
  s_andn2_b32 s47, s47, 32768
  s_add_u32 s46, s46, 0x1000
  s_and_b32 s46, s46, 0x1ffff
  s_add_u32 s45, s45, 1
  s_cmp_lg_u32 s55, 0
  s_cbranch_scc1 L_w18
  s_branch L_slow
L_w19:
  s_mov_b32 m0, s46
  s_waitcnt vmcnt(18)
  buffer_load_dwordx4 v4, s[36:39], s47 offen offset:0 nt lds
  s_waitcnt vmcnt(18)
  buffer_load_dwordx4 v5, s[36:39], s47 offen offset:1024 nt lds
  s_waitcnt vmcnt(18)
  buffer_load_dwordx4 v6, s[36:39], s47 offen offset:2048 nt lds
  s_sub_i32 s52, s45, 1
  s_max_i32 s51, s51, s52
  v_mov_b32 v12, s51
  ds_write_b32 v9, v12
  s_waitcnt vmcnt(18)
  buffer_load_dwordx4 v7, s[36:39], s47 offen offset:3072 nt lds
  s_add_u32 s47, s47, 0x1000
  s_add_u32 s46, s46, 0x1000
  s_mov_b32 m0, s46
  s_waitcnt vmcnt(18)
  buffer_load_dwordx4 v4, s[36:39], s47 offen offset:0 nt lds
  s_waitcnt vmcnt(18)
  buffer_load_dwordx4 v5, s[36:39], s47 offen offset:1024 nt lds
  ds_read_b32 v11, v10
  s_waitcnt vmcnt(18)
  buffer_load_dwordx4 v6, s[36:39], s47 offen offset:2048 nt lds
  s_waitcnt vmcnt(18)
  buffer_load_dwordx4 v7, s[36:39], s47 offen offset:3072 nt lds
  s_add_u32 s47, s47, 0x1000
  s_add_u32 s46, s46, 0x1000
  s_mov_b32 m0, s46
  s_waitcnt vmcnt(18)
  buffer_load_dwordx4 v4, s[36:39], s47 offen offset:0 nt lds
  s_waitcnt vmcnt(18)
  buffer_load_dwordx4 v5, s[36:39], s47 offen offset:1024 nt lds
  s_add_u32 s55, s45, 1
  s_and_b32 s48, s55, 3
  s_sub_i32 s50, s55, 4
  s_ashr_i32 s50, s50, 2
  s_waitcnt vmcnt(18)
  buffer_load_dwordx4 v6, s[36:39], s47 offen offset:2048 nt lds
  s_waitcnt vmcnt(18)
  buffer_load_dwordx4 v7, s[36:39], s47 offen offset:3072 nt lds
  s_add_u32 s47, s47, 0x1000
  s_add_u32 s46, s46, 0x1000
  s_mov_b32 m0, s46
  s_waitcnt vmcnt(18)
  buffer_load_dwordx4 v4, s[36:39], s47 offen offset:0 nt lds
  s_waitcnt lgkmcnt(0)
  v_readlane_b32 s49, v11, s48
  v_readlane_b32 s53, v11, 4
  s_and_b32 s55, s55, 63
  s_waitcnt vmcnt(18)
  buffer_load_dwordx4 v5, s[36:39], s47 offen offset:1024 nt lds
  s_cmp_eq_u32 s53, 0
  s_cselect_b32 s53, s54, s53
  s_cmp_ge_u32 s45, 123
  s_cselect_b32 s53, 44, s53
  s_cmp_eq_u32 s53, 19
  s_cselect_b32 s55, s55, 0
  s_cmp_ge_i32 s49, s50
  s_cselect_b32 s55, s55, 0
  s_waitcnt vmcnt(18)
  buffer_load_dwordx4 v6, s[36:39], s47 offen offset:2048 nt lds
  s_waitcnt vmcnt(18)
  buffer_load_dwordx4 v7, s[36:39], s47 offen offset:3072 nt lds
  s_or_b32 s47, s47, 32768
  s_add_u32 s47, s47, 0x1000
  s_andn2_b32 s47, s47, 32768
  s_add_u32 s46, s46, 0x1000
  s_and_b32 s46, s46, 0x1ffff
  s_add_u32 s45, s45, 1
  s_cmp_lg_u32 s55, 0
  s_cbranch_scc1 L_w19
  s_branch L_slow
L_w22:
  s_mov_b32 m0, s46
  s_waitcnt vmcnt(21)
  buffer_load_dwordx4 v4, s[36:39], s47 offen offset:0 nt lds
  s_waitcnt vmcnt(21)
  buffer_load_dwordx4 v5, s[36:39], s47 offen offset:1024 nt lds
  s_waitcnt vmcnt(21)
  buffer_load_dwordx4 v6, s[36:39], s47 offen offset:2048 nt lds
  s_waitcnt vmcnt(21)
  buffer_load_dwordx4 v7, s[36:39], s47 offen offset:3072 nt lds
  s_add_u32 s47, s47, 0x1000
  s_add_u32 s46, s46, 0x1000
  s_mov_b32 m0, s46
  s_waitcnt vmcnt(21)
  buffer_load_dwordx4 v4, s[36:39], s47 offen offset:0 nt lds
  s_waitcnt vmcnt(21)
  buffer_load_dwordx4 v5, s[36:39], s47 offen offset:1024 nt lds
  s_sub_i32 s52, s45, 1
  s_max_i32 s51, s51, s52
  v_mov_b32 v12, s51
  ds_write_b32 v9, v12
  ds_read_b32 v11, v10
  s_waitcnt vmcnt(21)
  buffer_load_dwordx4 v6, s[36:39], s47 offen offset:2048 nt lds
  s_waitcnt vmcnt(21)
  buffer_load_dwordx4 v7, s[36:39], s47 offen offset:3072 nt lds
  s_add_u32 s47, s47, 0x1000
  s_add_u32 s46, s46, 0x1000
  s_mov_b32 m0, s46
  s_waitcnt vmcnt(21)
  buffer_load_dwordx4 v4, s[36:39], s47 offen offset:0 nt lds
  s_waitcnt vmcnt(21)
  buffer_load_dwordx4 v5, s[36:39], s47 offen offset:1024 nt lds
  s_add_u32 s55, s45, 1
  s_and_b32 s48, s55, 3
  s_sub_i32 s50, s55, 4
  s_ashr_i32 s50, s50, 2
  s_waitcnt vmcnt(21)
  buffer_load_dwordx4 v6, s[36:39], s47 offen offset:2048 nt lds
  s_waitcnt vmcnt(21)
  buffer_load_dwordx4 v7, s[36:39], s47 offen offset:3072 nt lds
  s_add_u32 s47, s47, 0x1000
  s_add_u32 s46, s46, 0x1000
  s_mov_b32 m0, s46
  s_waitcnt vmcnt(21)
  buffer_load_dwordx4 v4, s[36:39], s47 offen offset:0 nt lds
  s_waitcnt lgkmcnt(0)
  v_readlane_b32 s49, v11, s48
  v_readlane_b32 s53, v11, 4
  s_and_b32 s55, s55, 63
  s_waitcnt vmcnt(21)
  buffer_load_dwordx4 v5, s[36:39], s47 offen offset:1024 nt lds
  s_cmp_eq_u32 s53, 0
  s_cselect_b32 s53, s54, s53
  s_cmp_ge_u32 s45, 123
  s_cselect_b32 s53, 44, s53
  s_cmp_eq_u32 s53, 22
  s_cselect_b32 s55, s55, 0
  s_cmp_ge_i32 s49, s50
  s_cselect_b32 s55, s55, 0
  s_waitcnt vmcnt(21)
  buffer_load_dwordx4 v6, s[36:39], s47 offen offset:2048 nt lds
  s_waitcnt vmcnt(21)
  buffer_load_dwordx4 v7, s[36:39], s47 offen offset:3072 nt lds
  s_or_b32 s47, s47, 32768
  s_add_u32 s47, s47, 0x1000
  s_andn2_b32 s47, s47, 32768
  s_add_u32 s46, s46, 0x1000
  s_and_b32 s46, s46, 0x1ffff
  s_add_u32 s45, s45, 1
  s_cmp_lg_u32 s55, 0
  s_cbranch_scc1 L_w22
  s_branch L_slow
L_w24:
  s_mov_b32 m0, s46
  s_waitcnt vmcnt(23)
  buffer_load_dwordx4 v4, s[36:39], s47 offen offset:0 nt lds
  s_waitcnt vmcnt(23)
  buffer_load_dwordx4 v5, s[36:39], s47 offen offset:1024 nt lds
  s_waitcnt vmcnt(23)
  buffer_load_dwordx4 v6, s[36:39], s47 offen offset:2048 nt lds
  s_waitcnt vmcnt(23)
  buffer_load_dwordx4 v7, s[36:39], s47 offen offset:3072 nt lds
  s_add_u32 s47, s47, 0x1000
  s_add_u32 s46, s46, 0x1000
  s_mov_b32 m0, s46
  s_waitcnt vmcnt(23)
  buffer_load_dwordx4 v4, s[36:39], s47 offen offset:0 nt lds
  s_waitcnt vmcnt(23)
  buffer_load_dwordx4 v5, s[36:39], s47 offen offset:1024 nt lds
  ds_read_b32 v11, v10
  s_waitcnt vmcnt(23)
  buffer_load_dwordx4 v6, s[36:39], s47 offen offset:2048 nt lds
  s_waitcnt vmcnt(23)
  buffer_load_dwordx4 v7, s[36:39], s47 offen offset:3072 nt lds
  s_sub_i32 s52, s45, 1
  s_max_i32 s51, s51, s52
  v_mov_b32 v12, s51
  ds_write_b32 v9, v12
  s_add_u32 s47, s47, 0x1000
  s_add_u32 s46, s46, 0x1000
  s_mov_b32 m0, s46
  s_waitcnt vmcnt(23)
  buffer_load_dwordx4 v4, s[36:39], s47 offen offset:0 nt lds
  s_waitcnt vmcnt(23)
  buffer_load_dwordx4 v5, s[36:39], s47 offen offset:1024 nt lds
  s_add_u32 s55, s45, 1
  s_and_b32 s48, s55, 3
  s_sub_i32 s50, s55, 4
  s_ashr_i32 s50, s50, 2
  s_waitcnt vmcnt(23)
  buffer_load_dwordx4 v6, s[36:39], s47 offen offset:2048 nt lds
  s_waitcnt vmcnt(23)
  buffer_load_dwordx4 v7, s[36:39], s47 offen offset:3072 nt lds
  s_add_u32 s47, s47, 0x1000
  s_add_u32 s46, s46, 0x1000
  s_mov_b32 m0, s46
  s_waitcnt vmcnt(23)
  buffer_load_dwordx4 v4, s[36:39], s47 offen offset:0 nt lds
  s_waitcnt lgkmcnt(0)
  v_readlane_b32 s49, v11, s48
  v_readlane_b32 s53, v11, 4
  s_and_b32 s55, s55, 63
  s_waitcnt vmcnt(23)
  buffer_load_dwordx4 v5, s[36:39], s47 offen offset:1024 nt lds
  s_cmp_eq_u32 s53, 0
  s_cselect_b32 s53, s54, s53
  s_cmp_ge_u32 s45, 123
  s_cselect_b32 s53, 44, s53
  s_cmp_eq_u32 s53, 24
  s_cselect_b32 s55, s55, 0
  s_cmp_ge_i32 s49, s50
  s_cselect_b32 s55, s55, 0
  s_waitcnt vmcnt(23)
  buffer_load_dwordx4 v6, s[36:39], s47 offen offset:2048 nt lds
  s_waitcnt vmcnt(23)
  buffer_load_dwordx4 v7, s[36:39], s47 offen offset:3072 nt lds
  s_or_b32 s47, s47, 32768
  s_add_u32 s47, s47, 0x1000
  s_andn2_b32 s47, s47, 32768
  s_add_u32 s46, s46, 0x1000
  s_and_b32 s46, s46, 0x1ffff
  s_add_u32 s45, s45, 1
  s_cmp_lg_u32 s55, 0
  s_cbranch_scc1 L_w24
  s_branch L_slow
L_w31:
  s_mov_b32 m0, s46
  s_waitcnt vmcnt(30)
  buffer_load_dwordx4 v4, s[36:39], s47 offen offset:0 nt lds
  s_waitcnt vmcnt(30)
  buffer_load_dwordx4 v5, s[36:39], s47 offen offset:1024 nt lds
  s_waitcnt vmcnt(30)
  buffer_load_dwordx4 v6, s[36:39], s47 offen offset:2048 nt lds
  s_waitcnt vmcnt(30)
  buffer_load_dwordx4 v7, s[36:39], s47 offen offset:3072 nt lds
  s_add_u32 s47, s47, 0x1000
  s_add_u32 s46, s46, 0x1000
  s_mov_b32 m0, s46
  s_waitcnt vmcnt(30)
  buffer_load_dwordx4 v4, s[36:39], s47 offen offset:0 nt lds
  s_waitcnt vmcnt(30)
  buffer_load_dwordx4 v5, s[36:39], s47 offen offset:1024 nt lds
  ds_read_b32 v11, v10
  s_waitcnt vmcnt(30)
  buffer_load_dwordx4 v6, s[36:39], s47 offen offset:2048 nt lds
  s_waitcnt vmcnt(30)
  buffer_load_dwordx4 v7, s[36:39], s47 offen offset:3072 nt lds
  s_add_u32 s47, s47, 0x1000
  s_add_u32 s46, s46, 0x1000
  s_mov_b32 m0, s46
  s_waitcnt vmcnt(30)
  buffer_load_dwordx4 v4, s[36:39], s47 offen offset:0 nt lds
  s_waitcnt vmcnt(30)
  buffer_load_dwordx4 v5, s[36:39], s47 offen offset:1024 nt lds
  s_add_u32 s55, s45, 1
  s_and_b32 s48, s55, 3
  s_sub_i32 s50, s55, 4
  s_ashr_i32 s50, s50, 2
  s_waitcnt vmcnt(30)
  buffer_load_dwordx4 v6, s[36:39], s47 offen offset:2048 nt lds
  s_waitcnt vmcnt(30)
  buffer_load_dwordx4 v7, s[36:39], s47 offen offset:3072 nt lds
  s_add_u32 s47, s47, 0x1000
  s_add_u32 s46, s46, 0x1000
  s_mov_b32 m0, s46
  s_waitcnt vmcnt(30)
  buffer_load_dwordx4 v4, s[36:39], s47 offen offset:0 nt lds
  s_waitcnt lgkmcnt(0)
  v_readlane_b32 s49, v11, s48
  v_readlane_b32 s53, v11, 4
  s_and_b32 s55, s55, 63
  s_waitcnt vmcnt(30)
  buffer_load_dwordx4 v5, s[36:39], s47 offen offset:1024 nt lds
  s_cmp_eq_u32 s53, 0
  s_cselect_b32 s53, s54, s53
  s_cmp_ge_u32 s45, 123
  s_cselect_b32 s53, 44, s53
  s_cmp_eq_u32 s53, 31
  s_cselect_b32 s55, s55, 0
  s_cmp_ge_i32 s49, s50
  s_cselect_b32 s55, s55, 0
  s_waitcnt vmcnt(30)
  buffer_load_dwordx4 v6, s[36:39], s47 offen offset:2048 nt lds
  s_sub_i32 s52, s45, 1
  s_max_i32 s51, s51, s52
  v_mov_b32 v12, s51
  ds_write_b32 v9, v12
  s_waitcnt vmcnt(30)
  buffer_load_dwordx4 v7, s[36:39], s47 offen offset:3072 nt lds
  s_or_b32 s47, s47, 32768
  s_add_u32 s47, s47, 0x1000
  s_andn2_b32 s47, s47, 32768
  s_add_u32 s46, s46, 0x1000
  s_and_b32 s46, s46, 0x1ffff
  s_add_u32 s45, s45, 1
  s_cmp_lg_u32 s55, 0
  s_cbranch_scc1 L_w31
  s_branch L_slow
L_w36:
  s_mov_b32 m0, s46
  s_waitcnt vmcnt(35)
  buffer_load_dwordx4 v4, s[36:39], s47 offen offset:0 nt lds
  s_waitcnt vmcnt(35)
  buffer_load_dwordx4 v5, s[36:39], s47 offen offset:1024 nt lds
  s_waitcnt vmcnt(35)
  buffer_load_dwordx4 v6, s[36:39], s47 offen offset:2048 nt lds
  s_waitcnt vmcnt(35)
  buffer_load_dwordx4 v7, s[36:39], s47 offen offset:3072 nt lds
  s_sub_i32 s52, s45, 2
  s_max_i32 s51, s51, s52
  v_mov_b32 v12, s51
  ds_write_b32 v9, v12
  s_add_u32 s47, s47, 0x1000
  s_add_u32 s46, s46, 0x1000
  s_mov_b32 m0, s46
  s_waitcnt vmcnt(35)
  buffer_load_dwordx4 v4, s[36:39], s47 offen offset:0 nt lds
  s_waitcnt vmcnt(35)
  buffer_load_dwordx4 v5, s[36:39], s47 offen offset:1024 nt lds
  ds_read_b32 v11, v10
  s_waitcnt vmcnt(35)
  buffer_load_dwordx4 v6, s[36:39], s47 offen offset:2048 nt lds
  s_waitcnt vmcnt(35)
  buffer_load_dwordx4 v7, s[36:39], s47 offen offset:3072 nt lds
  s_add_u32 s47, s47, 0x1000
  s_add_u32 s46, s46, 0x1000
  s_mov_b32 m0, s46
  s_waitcnt vmcnt(35)
  buffer_load_dwordx4 v4, s[36:39], s47 offen offset:0 nt lds
  s_waitcnt vmcnt(35)
  buffer_load_dwordx4 v5, s[36:39], s47 offen offset:1024 nt lds
  s_add_u32 s55, s45, 1
  s_and_b32 s48, s55, 3
  s_sub_i32 s50, s55, 4
  s_ashr_i32 s50, s50, 2
  s_waitcnt vmcnt(35)
  buffer_load_dwordx4 v6, s[36:39], s47 offen offset:2048 nt lds
  s_waitcnt vmcnt(35)
  buffer_load_dwordx4 v7, s[36:39], s47 offen offset:3072 nt lds
  s_add_u32 s47, s47, 0x1000
  s_add_u32 s46, s46, 0x1000
  s_mov_b32 m0, s46
  s_waitcnt vmcnt(35)
  buffer_load_dwordx4 v4, s[36:39], s47 offen offset:0 nt lds
  s_waitcnt lgkmcnt(0)
  v_readlane_b32 s49, v11, s48
  v_readlane_b32 s53, v11, 4
  s_and_b32 s55, s55, 63
  s_waitcnt vmcnt(35)
  buffer_load_dwordx4 v5, s[36:39], s47 offen offset:1024 nt lds
  s_cmp_eq_u32 s53, 0
  s_cselect_b32 s53, s54, s53
  s_cmp_ge_u32 s45, 123
  s_cselect_b32 s53, 44, s53
  s_cmp_eq_u32 s53, 36
  s_cselect_b32 s55, s55, 0
  s_cmp_ge_i32 s49, s50
  s_cselect_b32 s55, s55, 0
  s_waitcnt vmcnt(35)
  buffer_load_dwordx4 v6, s[36:39], s47 offen offset:2048 nt lds
  s_waitcnt vmcnt(35)
  buffer_load_dwordx4 v7, s[36:39], s47 offen offset:3072 nt lds
  s_or_b32 s47, s47, 32768
  s_add_u32 s47, s47, 0x1000
  s_andn2_b32 s47, s47, 32768
  s_add_u32 s46, s46, 0x1000
  s_and_b32 s46, s46, 0x1ffff
  s_add_u32 s45, s45, 1
  s_cmp_lg_u32 s55, 0
  s_cbranch_scc1 L_w36
  s_branch L_slow
L_w44:
  s_mov_b32 m0, s46
  s_waitcnt vmcnt(43)
  buffer_load_dwordx4 v4, s[36:39], s47 offen offset:0 nt lds
  s_waitcnt vmcnt(43)
  buffer_load_dwordx4 v5, s[36:39], s47 offen offset:1024 nt lds
  s_waitcnt vmcnt(43)
  buffer_load_dwordx4 v6, s[36:39], s47 offen offset:2048 nt lds
  s_waitcnt vmcnt(43)
  buffer_load_dwordx4 v7, s[36:39], s47 offen offset:3072 nt lds
  s_add_u32 s47, s47, 0x1000
  s_add_u32 s46, s46, 0x1000
  s_mov_b32 m0, s46
  s_waitcnt vmcnt(43)
  buffer_load_dwordx4 v4, s[36:39], s47 offen offset:0 nt lds
  s_waitcnt vmcnt(43)
  buffer_load_dwordx4 v5, s[36:39], s47 offen offset:1024 nt lds
  ds_read_b32 v11, v10
  s_waitcnt vmcnt(43)
  buffer_load_dwordx4 v6, s[36:39], s47 offen offset:2048 nt lds
  s_waitcnt vmcnt(43)
  buffer_load_dwordx4 v7, s[36:39], s47 offen offset:3072 nt lds
  s_add_u32 s47, s47, 0x1000
  s_add_u32 s46, s46, 0x1000
  s_mov_b32 m0, s46
  s_waitcnt vmcnt(43)
  buffer_load_dwordx4 v4, s[36:39], s47 offen offset:0 nt lds
  s_waitcnt vmcnt(43)
  buffer_load_dwordx4 v5, s[36:39], s47 offen offset:1024 nt lds
  s_add_u32 s55, s45, 1
  s_and_b32 s48, s55, 3
  s_sub_i32 s50, s55, 4
  s_ashr_i32 s50, s50, 2
  s_waitcnt vmcnt(43)
  buffer_load_dwordx4 v6, s[36:39], s47 offen offset:2048 nt lds
  s_waitcnt vmcnt(43)
  buffer_load_dwordx4 v7, s[36:39], s47 offen offset:3072 nt lds
  s_sub_i32 s52, s45, 2
  s_max_i32 s51, s51, s52
  v_mov_b32 v12, s51
  ds_write_b32 v9, v12
  s_add_u32 s47, s47, 0x1000
  s_add_u32 s46, s46, 0x1000
  s_mov_b32 m0, s46
  s_waitcnt vmcnt(43)
  buffer_load_dwordx4 v4, s[36:39], s47 offen offset:0 nt lds
  s_waitcnt lgkmcnt(0)
  v_readlane_b32 s49, v11, s48
  v_readlane_b32 s53, v11, 4
  s_and_b32 s55, s55, 63
  s_waitcnt vmcnt(43)
  buffer_load_dwordx4 v5, s[36:39], s47 offen offset:1024 nt lds
  s_cmp_eq_u32 s53, 0
  s_cselect_b32 s53, s54, s53
  s_cmp_ge_u32 s45, 123
  s_cselect_b32 s53, 44, s53
  s_cmp_eq_u32 s53, 44
  s_cselect_b32 s55, s55, 0
  s_cmp_ge_i32 s49, s50
  s_cselect_b32 s55, s55, 0
  s_waitcnt vmcnt(43)
  buffer_load_dwordx4 v6, s[36:39], s47 offen offset:2048 nt lds
  s_waitcnt vmcnt(43)
  buffer_load_dwordx4 v7, s[36:39], s47 offen offset:3072 nt lds
  s_or_b32 s47, s47, 32768
  s_add_u32 s47, s47, 0x1000
  s_andn2_b32 s47, s47, 32768
  s_add_u32 s46, s46, 0x1000
  s_and_b32 s46, s46, 0x1ffff
  s_add_u32 s45, s45, 1
  s_cmp_lg_u32 s55, 0
  s_cbranch_scc1 L_w44
  s_branch L_slow
L_main:
  s_setprio 1
  s_sub_u32 s35, s3, 2
  v_lshlrev_b32 v61, 4, v0
  s_lshl_b32 s36, s32, 10
  v_add_u32 v61, s36, v61
  v_lshlrev_b32 v60, 13, v2
  v_lshl_add_u32 v60, v3, 4, v60
  s_lshl_b32 s44, s35, 20
  s_lshl_b32 s45, s31, 8
  s_add_u32 s44, s44, s45
  s_lshl1_add_u32 s47, s32, s30
  s_lshl_b32 s46, s47, 17
  s_mov_b32 s42, 4194304
  s_mov_b32 s43, 0x20000
  s_waitcnt lgkmcnt(0)
  global_load_dwordx4 v[96:99], v61, s[4:5]
  s_mov_b32 s40, s10
  s_mov_b32 s41, s11
  v_mov_b32 v59, v60
  buffer_load_dwordx4 v[128:131], v59, s[40:43], s44 offen
  s_add_u32 s44, s44, 0x8000
  buffer_load_dwordx4 v[132:135], v59, s[40:43], s44 offen
  s_add_u32 s44, s44, 0x8000
  buffer_load_dwordx4 v[136:139], v59, s[40:43], s44 offen
  s_add_u32 s44, s44, 0x8000
  buffer_load_dwordx4 v[140:143], v59, s[40:43], s44 offen
  s_add_u32 s44, s44, 0x8000
  buffer_load_dwordx4 v[144:147], v59, s[40:43], s44 offen
  s_add_u32 s44, s44, 0x8000
  buffer_load_dwordx4 v[148:151], v59, s[40:43], s44 offen
  s_add_u32 s44, s44, 0x8000
  buffer_load_dwordx4 v[152:155], v59, s[40:43], s44 offen
  s_add_u32 s44, s44, 0x8000
  buffer_load_dwordx4 v[156:159], v59, s[40:43], s44 offen
  s_add_u32 s44, s44, 0x8000
  v_and_b32 v8, 1, v3
  v_cmp_eq_u32 vcc, 1, v8
  v_mov_b32 v9, 0xffff
  v_mov_b32 v10, 0xffff0000
  v_bfe_u32 v8, v3, 1, 2
  v_cndmask_b32 v9, v9, v10, vcc
  v_cmp_eq_u32 vcc, 0, v8
  s_nop 1
  v_cndmask_b32 v4, 0, v9, vcc
  v_cmp_eq_u32 vcc, 1, v8
  s_nop 1
  v_cndmask_b32 v5, 0, v9, vcc
  v_cmp_eq_u32 vcc, 2, v8
  s_nop 1
  v_cndmask_b32 v6, 0, v9, vcc
  v_cmp_eq_u32 vcc, 3, v8
  s_nop 1
  v_cndmask_b32 v7, 0, v9, vcc
  s_lshl_b32 s36, s35, 14
  v_add_u32 v52, 0, v2
  v_xor_b32 v52, v52, v3
  v_lshlrev_b32 v52, 4, v52
  v_lshl_add_u32 v52, v3, 8, v52
  v_add_u32 v52, s36, v52
  v_add_u32 v53, 4, v2
  v_xor_b32 v53, v53, v3
  v_lshlrev_b32 v53, 4, v53
  v_lshl_add_u32 v53, v3, 8, v53
  v_add_u32 v53, s36, v53
  v_add_u32 v54, 8, v2
  v_xor_b32 v54, v54, v3
  v_lshlrev_b32 v54, 4, v54
  v_lshl_add_u32 v54, v3, 8, v54
  v_add_u32 v54, s36, v54
  v_add_u32 v55, 12, v2
  v_xor_b32 v55, v55, v3
  v_lshlrev_b32 v55, 4, v55
  v_lshl_add_u32 v55, v3, 8, v55
  v_add_u32 v55, s36, v55
  v_lshl_add_u32 v60, v0, 4, s36
  s_waitcnt vmcnt(8)
  v_lshlrev_b32 v100, 16, v96
  v_and_b32 v101, 0xffff0000, v96
  v_lshlrev_b32 v102, 16, v97
  v_and_b32 v103, 0xffff0000, v97
  v_lshlrev_b32 v104, 16, v98
  v_and_b32 v105, 0xffff0000, v98
  v_lshlrev_b32 v106, 16, v99
  v_and_b32 v107, 0xffff0000, v99
  v_add_f32 v108, v100, v101
  v_add_f32 v109, v102, v103
  v_add_f32 v110, v104, v105
  v_add_f32 v111, v106, v107
  v_add_f32 v108, v108, v109
  v_add_f32 v110, v110, v111
  v_add_f32 v108, v108, v110
  s_nop 2
  v_add_f32_dpp v108, v108, v108 row_ror:8 row_mask:0xf bank_mask:0xf
  s_nop 2
  v_add_f32_dpp v108, v108, v108 row_ror:4 row_mask:0xf bank_mask:0xf
  s_nop 2
  v_add_f32_dpp v108, v108, v108 row_ror:2 row_mask:0xf bank_mask:0xf
  s_nop 2
  v_add_f32_dpp v108, v108, v108 row_ror:1 row_mask:0xf bank_mask:0xf
  v_mov_b32 v109, v108
  s_nop 1
  v_permlane16_swap_b32 v108, v109
  s_nop 1
  v_add_f32 v108, v108, v109
  v_mov_b32 v109, v108
  s_nop 1
  v_permlane32_swap_b32 v108, v109
  s_nop 1
  v_add_f32 v108, v108, v109
  v_mul_f32 v108, 0x3b000000, v108
  v_sub_f32 v110, v100, v108
  v_mul_f32 v109, v110, v110
  v_sub_f32 v110, v101, v108
  v_fmac_f32 v109, v110, v110
  v_sub_f32 v110, v102, v108
  v_fmac_f32 v109, v110, v110
  v_sub_f32 v110, v103, v108
  v_fmac_f32 v109, v110, v110
  v_sub_f32 v110, v104, v108
  v_fmac_f32 v109, v110, v110
  v_sub_f32 v110, v105, v108
  v_fmac_f32 v109, v110, v110
  v_sub_f32 v110, v106, v108
  v_fmac_f32 v109, v110, v110
  v_sub_f32 v110, v107, v108
  v_fmac_f32 v109, v110, v110
  s_nop 2
  v_add_f32_dpp v109, v109, v109 row_ror:8 row_mask:0xf bank_mask:0xf
  s_nop 2
  v_add_f32_dpp v109, v109, v109 row_ror:4 row_mask:0xf bank_mask:0xf
  s_nop 2
  v_add_f32_dpp v109, v109, v109 row_ror:2 row_mask:0xf bank_mask:0xf
  s_nop 2
  v_add_f32_dpp v109, v109, v109 row_ror:1 row_mask:0xf bank_mask:0xf
  v_mov_b32 v110, v109
  s_nop 1
  v_permlane16_swap_b32 v109, v110
  s_nop 1
  v_add_f32 v109, v109, v110
  v_mov_b32 v110, v109
  s_nop 1
  v_permlane32_swap_b32 v109, v110
  s_nop 1
  v_add_f32 v109, v109, v110
  v_mul_f32 v109, 0x3b000000, v109
  v_cvt_pk_bf16_f32 v109, v109, v109
  v_and_b32 v109, 0xffff0000, v109
  v_add_f32 v109, 0x3727c5ac, v109
  v_cvt_pk_bf16_f32 v109, v109, v109
  v_and_b32 v109, 0xffff0000, v109
  v_sqrt_f32 v109, v109
  v_cvt_pk_bf16_f32 v108, v108, v108
  v_and_b32 v108, 0xffff0000, v108
  v_cvt_pk_bf16_f32 v109, v109, v109
  v_and_b32 v109, 0xffff0000, v109
  v_rcp_f32 v110, v109
  v_sub_f32 v100, v100, v108
  v_sub_f32 v101, v101, v108
  v_sub_f32 v102, v102, v108
  v_sub_f32 v103, v103, v108
  v_sub_f32 v104, v104, v108
  v_sub_f32 v105, v105, v108
  v_sub_f32 v106, v106, v108
  v_sub_f32 v107, v107, v108
  v_cvt_pk_bf16_f32 v100, v100, v100
  v_and_b32 v100, 0xffff0000, v100
  v_cvt_pk_bf16_f32 v101, v101, v101
  v_and_b32 v101, 0xffff0000, v101
  v_cvt_pk_bf16_f32 v102, v102, v102
  v_and_b32 v102, 0xffff0000, v102
  v_cvt_pk_bf16_f32 v103, v103, v103
  v_and_b32 v103, 0xffff0000, v103
  v_cvt_pk_bf16_f32 v104, v104, v104
  v_and_b32 v104, 0xffff0000, v104
  v_cvt_pk_bf16_f32 v105, v105, v105
  v_and_b32 v105, 0xffff0000, v105
  v_cvt_pk_bf16_f32 v106, v106, v106
  v_and_b32 v106, 0xffff0000, v106
  v_cvt_pk_bf16_f32 v107, v107, v107
  v_and_b32 v107, 0xffff0000, v107
  v_mul_f32 v111, v100, v110
  v_fma_f32 v100, -v111, v109, v100
  v_fma_f32 v100, v100, v110, v111
  v_mul_f32 v111, v101, v110
  v_fma_f32 v101, -v111, v109, v101
  v_fma_f32 v101, v101, v110, v111
  v_mul_f32 v111, v102, v110
  v_fma_f32 v102, -v111, v109, v102
  v_fma_f32 v102, v102, v110, v111
  v_mul_f32 v111, v103, v110
  v_fma_f32 v103, -v111, v109, v103
  v_fma_f32 v103, v103, v110, v111
  v_mul_f32 v111, v104, v110
  v_fma_f32 v104, -v111, v109, v104
  v_fma_f32 v104, v104, v110, v111
  v_mul_f32 v111, v105, v110
  v_fma_f32 v105, -v111, v109, v105
  v_fma_f32 v105, v105, v110, v111
  v_mul_f32 v111, v106, v110
  v_fma_f32 v106, -v111, v109, v106
  v_fma_f32 v106, v106, v110, v111
  v_mul_f32 v111, v107, v110
  v_fma_f32 v107, -v111, v109, v107
  v_fma_f32 v107, v107, v110, v111
  v_cvt_pk_bf16_f32 v112, v100, v100
  v_cvt_pk_bf16_f32 v113, v104, v104
  v_cvt_pk_bf16_f32 v114, v101, v101
  v_cvt_pk_bf16_f32 v115, v105, v105
  v_cvt_pk_bf16_f32 v116, v102, v102
  v_cvt_pk_bf16_f32 v117, v106, v106
  v_cvt_pk_bf16_f32 v118, v103, v103
  v_cvt_pk_bf16_f32 v119, v107, v107
  v_lshlrev_b32 v61, 3, v0
  v_add_u32 v61, 133120, v61
  ds_write_b64 v61, v[112:113] offset:0
  ds_write_b64 v61, v[114:115] offset:512
  ds_write_b64 v61, v[116:117] offset:1024
  ds_write_b64 v61, v[118:119] offset:1536
  s_lshl_b32 s36, s35, 7
  s_add_u32 s36, s36, 133120
  v_lshlrev_b32 v61, 9, v2
  v_add_u32 v61, s36, v61
  s_waitcnt lgkmcnt(0)
  ds_read_b128 v[20:23], v61 offset:0
  ds_read_b128 v[24:27], v61 offset:16
  ds_read_b128 v[28:31], v61 offset:32
  ds_read_b128 v[32:35], v61 offset:48
  ds_read_b128 v[36:39], v61 offset:64
  ds_read_b128 v[40:43], v61 offset:80
  ds_read_b128 v[44:47], v61 offset:96
  ds_read_b128 v[48:51], v61 offset:112
  s_lshl_b32 s38, s35, 8
  s_add_u32 s38, s38, 131328
  v_lshl_add_u32 v1, v0, 2, s38
  v_mov_b32 v56, 131072
  v_mov_b32 v58, 1
  s_waitcnt lgkmcnt(0)
  v_and_b32 v8, v20, v4
  v_and_b32 v9, v20, v5
  v_and_b32 v10, v20, v6
  v_and_b32 v11, v20, v7
  v_and_b32 v12, v21, v4
  v_and_b32 v13, v21, v5
  v_and_b32 v14, v21, v6
  v_and_b32 v15, v21, v7
  s_waitcnt vmcnt(7)
  buffer_load_dwordx4 v[160:163], v59, s[40:43], s44 offen
  s_add_u32 s44, s44, 0x8000
  v_mfma_f32_16x16x32_bf16 v[16:19], v[8:11], v[128:131], 0
  v_and_b32 v8, v22, v4
  v_and_b32 v9, v22, v5
  v_and_b32 v10, v22, v6
  v_and_b32 v11, v22, v7
  s_waitcnt vmcnt(7)
  buffer_load_dwordx4 v[164:167], v59, s[40:43], s44 offen
  s_add_u32 s44, s44, 0x8000
  v_mfma_f32_16x16x32_bf16 v[16:19], v[12:15], v[132:135], v[16:19]
  v_and_b32 v12, v23, v4
  v_and_b32 v13, v23, v5
  v_and_b32 v14, v23, v6
  v_and_b32 v15, v23, v7
  s_waitcnt vmcnt(7)
  buffer_load_dwordx4 v[168:171], v59, s[40:43], s44 offen
  s_add_u32 s44, s44, 0x8000
  v_mfma_f32_16x16x32_bf16 v[16:19], v[8:11], v[136:139], v[16:19]
  v_and_b32 v8, v24, v4
  v_and_b32 v9, v24, v5
  v_and_b32 v10, v24, v6
  v_and_b32 v11, v24, v7
  s_waitcnt vmcnt(7)
  buffer_load_dwordx4 v[172:175], v59, s[40:43], s44 offen
  s_add_u32 s44, s44, 0x8000
  v_mfma_f32_16x16x32_bf16 v[16:19], v[12:15], v[140:143], v[16:19]
  v_and_b32 v12, v25, v4
  v_and_b32 v13, v25, v5
  v_and_b32 v14, v25, v6
  v_and_b32 v15, v25, v7
  s_waitcnt vmcnt(7)
  buffer_load_dwordx4 v[176:179], v59, s[40:43], s44 offen
  s_add_u32 s44, s44, 0x8000
  v_mfma_f32_16x16x32_bf16 v[16:19], v[8:11], v[144:147], v[16:19]
  v_and_b32 v8, v26, v4
  v_and_b32 v9, v26, v5
  v_and_b32 v10, v26, v6
  v_and_b32 v11, v26, v7
  s_waitcnt vmcnt(7)
  buffer_load_dwordx4 v[180:183], v59, s[40:43], s44 offen
  s_add_u32 s44, s44, 0x8000
  v_mfma_f32_16x16x32_bf16 v[16:19], v[12:15], v[148:151], v[16:19]
  v_and_b32 v12, v27, v4
  v_and_b32 v13, v27, v5
  v_and_b32 v14, v27, v6
  v_and_b32 v15, v27, v7
  s_waitcnt vmcnt(7)
  buffer_load_dwordx4 v[184:187], v59, s[40:43], s44 offen
  s_add_u32 s44, s44, 0x8000
  v_mfma_f32_16x16x32_bf16 v[16:19], v[8:11], v[152:155], v[16:19]
  v_and_b32 v8, v28, v4
  v_and_b32 v9, v28, v5
  v_and_b32 v10, v28, v6
  v_and_b32 v11, v28, v7
  s_waitcnt vmcnt(7)
  buffer_load_dwordx4 v[188:191], v59, s[40:43], s44 offen
  s_add_u32 s44, s44, 0x8000
  v_mfma_f32_16x16x32_bf16 v[16:19], v[12:15], v[156:159], v[16:19]
  v_and_b32 v12, v29, v4
  v_and_b32 v13, v29, v5
  v_and_b32 v14, v29, v6
  v_and_b32 v15, v29, v7
  s_waitcnt vmcnt(7)
  buffer_load_dwordx4 v[192:195], v59, s[40:43], s44 offen
  s_add_u32 s44, s44, 0x8000
  v_mfma_f32_16x16x32_bf16 v[16:19], v[8:11], v[160:163], v[16:19]
  v_and_b32 v8, v30, v4
  v_and_b32 v9, v30, v5
  v_and_b32 v10, v30, v6
  v_and_b32 v11, v30, v7
  s_waitcnt vmcnt(7)
  buffer_load_dwordx4 v[196:199], v59, s[40:43], s44 offen
  s_add_u32 s44, s44, 0x8000
  v_mfma_f32_16x16x32_bf16 v[16:19], v[12:15], v[164:167], v[16:19]
  v_and_b32 v12, v31, v4
  v_and_b32 v13, v31, v5
  v_and_b32 v14, v31, v6
  v_and_b32 v15, v31, v7
  s_waitcnt vmcnt(7)
  buffer_load_dwordx4 v[200:203], v59, s[40:43], s44 offen
  s_add_u32 s44, s44, 0x8000
  v_mfma_f32_16x16x32_bf16 v[16:19], v[8:11], v[168:171], v[16:19]
  v_and_b32 v8, v32, v4
  v_and_b32 v9, v32, v5
  v_and_b32 v10, v32, v6
  v_and_b32 v11, v32, v7
  s_waitcnt vmcnt(7)
  buffer_load_dwordx4 v[204:207], v59, s[40:43], s44 offen
  s_add_u32 s44, s44, 0x8000
  v_mfma_f32_16x16x32_bf16 v[16:19], v[12:15], v[172:175], v[16:19]
  v_and_b32 v12, v33, v4
  v_and_b32 v13, v33, v5
  v_and_b32 v14, v33, v6
  v_and_b32 v15, v33, v7
  s_waitcnt vmcnt(7)
  buffer_load_dwordx4 v[208:211], v59, s[40:43], s44 offen
  s_add_u32 s44, s44, 0x8000
  v_mfma_f32_16x16x32_bf16 v[16:19], v[8:11], v[176:179], v[16:19]
  v_and_b32 v8, v34, v4
  v_and_b32 v9, v34, v5
  v_and_b32 v10, v34, v6
  v_and_b32 v11, v34, v7
  s_waitcnt vmcnt(7)
  buffer_load_dwordx4 v[212:215], v59, s[40:43], s44 offen
  s_add_u32 s44, s44, 0x8000
  v_mfma_f32_16x16x32_bf16 v[16:19], v[12:15], v[180:183], v[16:19]
  v_and_b32 v12, v35, v4
  v_and_b32 v13, v35, v5
  v_and_b32 v14, v35, v6
  v_and_b32 v15, v35, v7
  s_waitcnt vmcnt(7)
  buffer_load_dwordx4 v[216:219], v59, s[40:43], s44 offen
  s_add_u32 s44, s44, 0x8000
  v_mfma_f32_16x16x32_bf16 v[16:19], v[8:11], v[184:187], v[16:19]
  v_and_b32 v8, v36, v4
  v_and_b32 v9, v36, v5
  v_and_b32 v10, v36, v6
  v_and_b32 v11, v36, v7
  s_waitcnt vmcnt(7)
  buffer_load_dwordx4 v[220:223], v59, s[40:43], s44 offen
  s_add_u32 s44, s44, 0x8000
  v_mfma_f32_16x16x32_bf16 v[16:19], v[12:15], v[188:191], v[16:19]
  v_and_b32 v12, v37, v4
  v_and_b32 v13, v37, v5
  v_and_b32 v14, v37, v6
  v_and_b32 v15, v37, v7
  s_waitcnt vmcnt(7)
  buffer_load_dwordx4 v[224:227], v59, s[40:43], s44 offen
  s_add_u32 s44, s44, 0x8000
  v_mfma_f32_16x16x32_bf16 v[16:19], v[8:11], v[192:195], v[16:19]
  v_and_b32 v8, v38, v4
  v_and_b32 v9, v38, v5
  v_and_b32 v10, v38, v6
  v_and_b32 v11, v38, v7
  s_waitcnt vmcnt(7)
  buffer_load_dwordx4 v[228:231], v59, s[40:43], s44 offen
  s_add_u32 s44, s44, 0x8000
  v_mfma_f32_16x16x32_bf16 v[16:19], v[12:15], v[196:199], v[16:19]
  v_and_b32 v12, v39, v4
  v_and_b32 v13, v39, v5
  v_and_b32 v14, v39, v6
  v_and_b32 v15, v39, v7
  s_waitcnt vmcnt(7)
  buffer_load_dwordx4 v[232:235], v59, s[40:43], s44 offen
  s_add_u32 s44, s44, 0x8000
  v_mfma_f32_16x16x32_bf16 v[16:19], v[8:11], v[200:203], v[16:19]
  v_and_b32 v8, v40, v4
  v_and_b32 v9, v40, v5
  v_and_b32 v10, v40, v6
  v_and_b32 v11, v40, v7
  s_waitcnt vmcnt(7)
  buffer_load_dwordx4 v[236:239], v59, s[40:43], s44 offen
  s_add_u32 s44, s44, 0x8000
  v_mfma_f32_16x16x32_bf16 v[16:19], v[12:15], v[204:207], v[16:19]
  v_and_b32 v12, v41, v4
  v_and_b32 v13, v41, v5
  v_and_b32 v14, v41, v6
  v_and_b32 v15, v41, v7
  s_waitcnt vmcnt(7)
  buffer_load_dwordx4 v[240:243], v59, s[40:43], s44 offen
  s_add_u32 s44, s44, 0x8000
  v_mfma_f32_16x16x32_bf16 v[16:19], v[8:11], v[208:211], v[16:19]
L_kp:
  ds_read_b32 v57, v56
  s_waitcnt lgkmcnt(0)
  v_readfirstlane_b32 s38, v57
  s_sub_u32 s34, s34, 1
  s_cbranch_scc1 L_exit
  s_cmp_le_i32 s38, s35
  s_cbranch_scc1 L_kp
  ds_read_b128 v[64:67], v52 offset:0
  ds_read_b128 v[68:71], v53 offset:0
  ds_read_b128 v[72:75], v54 offset:0
  ds_read_b128 v[76:79], v55 offset:0
  ds_read_b128 v[80:83], v52 offset:4096
  ds_read_b128 v[84:87], v53 offset:4096
  ds_read_b128 v[88:91], v54 offset:4096
  ds_read_b128 v[92:95], v55 offset:4096
  ds_read_b128 v[96:99], v52 offset:8192
  ds_read_b128 v[100:103], v53 offset:8192
  ds_read_b128 v[104:107], v54 offset:8192
  ds_read_b128 v[108:111], v55 offset:8192
  ds_read_b128 v[112:115], v52 offset:12288
  ds_read_b128 v[116:119], v53 offset:12288
  ds_read_b128 v[120:123], v54 offset:12288
  ds_read_b128 v[124:127], v55 offset:12288
  ds_write_b32 v1, v58
  v_xor_b32 v52, 0x10000, v52
  v_xor_b32 v53, 0x10000, v53
  v_xor_b32 v54, 0x10000, v54
  v_xor_b32 v55, 0x10000, v55
  v_and_b32 v8, v42, v4
  v_and_b32 v9, v42, v5
  v_and_b32 v10, v42, v6
  v_and_b32 v11, v42, v7
  s_waitcnt vmcnt(7)
  buffer_load_dwordx4 v[244:247], v59, s[40:43], s44 offen
  s_add_u32 s44, s44, 0x8000
  v_mfma_f32_16x16x32_bf16 v[16:19], v[12:15], v[212:215], v[16:19]
  v_and_b32 v12, v43, v4
  v_and_b32 v13, v43, v5
  v_and_b32 v14, v43, v6
  v_and_b32 v15, v43, v7
  s_waitcnt vmcnt(7)
  buffer_load_dwordx4 v[248:251], v59, s[40:43], s44 offen
  s_add_u32 s44, s44, 0x8000
  v_mfma_f32_16x16x32_bf16 v[16:19], v[8:11], v[216:219], v[16:19]
  v_and_b32 v8, v44, v4
  v_and_b32 v9, v44, v5
  v_and_b32 v10, v44, v6
  v_and_b32 v11, v44, v7
  s_waitcnt vmcnt(7)
  buffer_load_dwordx4 v[252:255], v59, s[40:43], s44 offen
  s_add_u32 s44, s44, 0x8000
  v_mfma_f32_16x16x32_bf16 v[16:19], v[12:15], v[220:223], v[16:19]
  v_and_b32 v12, v45, v4
  v_and_b32 v13, v45, v5
  v_and_b32 v14, v45, v6
  v_and_b32 v15, v45, v7
  s_waitcnt vmcnt(7)
  v_mfma_f32_16x16x32_bf16 v[16:19], v[8:11], v[224:227], v[16:19]
  v_and_b32 v8, v46, v4
  v_and_b32 v9, v46, v5
  v_and_b32 v10, v46, v6
  v_and_b32 v11, v46, v7
  s_waitcnt vmcnt(6)
  v_mfma_f32_16x16x32_bf16 v[16:19], v[12:15], v[228:231], v[16:19]
  v_and_b32 v12, v47, v4
  v_and_b32 v13, v47, v5
  v_and_b32 v14, v47, v6
  v_and_b32 v15, v47, v7
  s_waitcnt vmcnt(5)
  v_mfma_f32_16x16x32_bf16 v[16:19], v[8:11], v[232:235], v[16:19]
  v_and_b32 v8, v48, v4
  v_and_b32 v9, v48, v5
  v_and_b32 v10, v48, v6
  v_and_b32 v11, v48, v7
  s_waitcnt vmcnt(4)
  v_mfma_f32_16x16x32_bf16 v[16:19], v[12:15], v[236:239], v[16:19]
  v_and_b32 v12, v49, v4
  v_and_b32 v13, v49, v5
  v_and_b32 v14, v49, v6
  v_and_b32 v15, v49, v7
  s_waitcnt vmcnt(3)
  v_mfma_f32_16x16x32_bf16 v[16:19], v[8:11], v[240:243], v[16:19]
  v_and_b32 v8, v50, v4
  v_and_b32 v9, v50, v5
  v_and_b32 v10, v50, v6
  v_and_b32 v11, v50, v7
  s_waitcnt vmcnt(2)
  v_mfma_f32_16x16x32_bf16 v[16:19], v[12:15], v[244:247], v[16:19]
  v_and_b32 v12, v51, v4
  v_and_b32 v13, v51, v5
  v_and_b32 v14, v51, v6
  v_and_b32 v15, v51, v7
  s_waitcnt vmcnt(1)
  v_mfma_f32_16x16x32_bf16 v[16:19], v[8:11], v[248:251], v[16:19]
  s_nop 1
  s_waitcnt vmcnt(0)
  v_mfma_f32_16x16x32_bf16 v[16:19], v[12:15], v[252:255], v[16:19]
  s_lshl_b32 s36, s35, 9
  s_add_u32 s36, s36, 149504
  v_and_b32 v63, 1, v2
  v_lshlrev_b32 v63, 4, v63
  v_lshl_add_u32 v63, v3, 5, v63
  v_add_u32 v63, s36, v63
  v_mov_b32 v61, 132352
  v_mov_b32 v62, 1
  s_nop 3
  ds_write_b128 v63, v[16:19]
  s_mov_b64 exec, 1
  ds_add_u32 v61, v62
  s_mov_b64 exec, -1
L_qwait:
  ds_read_b32 v62, v61
  s_waitcnt lgkmcnt(0)
  v_readfirstlane_b32 s36, v62
  s_sub_u32 s34, s34, 1
  s_cbranch_scc1 L_exit
  s_cmp_lt_u32 s36, 4
  s_cbranch_scc1 L_qwait
  v_lshlrev_b32 v61, 3, v0
  v_add_u32 v61, 149504, v61
  ds_read_b64 v[36:37], v61 offset:0
  ds_read_b64 v[38:39], v61 offset:512
  ds_read_b64 v[40:41], v61 offset:1024
  ds_read_b64 v[42:43], v61 offset:1536
  s_lshl_b32 s36, s35, 8
  s_add_u32 s36, s36, 151552
  v_lshl_add_u32 v61, v0, 2, s36
  v_lshl_add_u32 v62, v2, 4, s36
  s_waitcnt lgkmcnt(0)
  v_add_f32 v36, v36, v38
  v_add_f32 v37, v37, v39
  v_add_f32 v40, v40, v42
  v_add_f32 v41, v41, v43
  v_add_f32 v36, v36, v40
  v_add_f32 v37, v37, v41
  v_cvt_pk_bf16_f32 v36, v36, v37
  ds_write_b32 v61, v36
  ds_read_b128 v[20:23], v62 offset:0
  ds_read_b128 v[24:27], v62 offset:64
  ds_read_b128 v[28:31], v62 offset:128
  ds_read_b128 v[32:35], v62 offset:192
  s_mov_b32 s36, s35
  s_mov_b32 s37, 1
  v_mov_b32 v62, 0xff800000
  v_mov_b32 v61, 131072
  s_lshl_b32 s38, s35, 12
  s_add_u32 s38, s38, 133120
  v_lshl_add_u32 v16, v0, 2, s38
  v_mov_b32 v17, v16
  s_mov_b32 s40, s12
  s_mov_b32 s41, s13
  s_mov_b32 s42, 4194304
  s_lshl_b32 s44, s31, 17
  s_lshl_b32 s45, s35, 8
  s_add_u32 s44, s44, s45
  v_lshlrev_b32 v18, 13, v2
  v_lshl_add_u32 v18, v3, 4, v18
  s_mov_b32 s46, 0x05040100
  s_mov_b32 s47, 0x07060302
  s_setprio 1
  s_waitcnt lgkmcnt(0)
  s_call_b64 s[54:55], L_kmf
  s_call_b64 s[54:55], L_kblock
  s_add_u32 s45, s44, 0
  buffer_load_dwordx4 v[128:131], v18, s[40:43], s45 offen offset:0
  s_add_u32 s45, s44, 0
  buffer_load_dwordx4 v[132:135], v18, s[40:43], s45 offen offset:1024
  s_call_b64 s[54:55], L_kblock
  s_add_u32 s45, s44, 0
  buffer_load_dwordx4 v[136:139], v18, s[40:43], s45 offen offset:2048
  s_call_b64 s[54:55], L_kblock
  s_add_u32 s45, s44, 0
  buffer_load_dwordx4 v[140:143], v18, s[40:43], s45 offen offset:3072
  s_add_u32 s45, s44, 4096
  buffer_load_dwordx4 v[144:147], v18, s[40:43], s45 offen offset:0
  s_call_b64 s[54:55], L_kblock
  s_add_u32 s45, s44, 4096
  buffer_load_dwordx4 v[148:151], v18, s[40:43], s45 offen offset:1024
  s_call_b64 s[54:55], L_kblock
  s_add_u32 s45, s44, 4096
  buffer_load_dwordx4 v[152:155], v18, s[40:43], s45 offen offset:2048
  s_add_u32 s45, s44, 4096
  buffer_load_dwordx4 v[156:159], v18, s[40:43], s45 offen offset:3072
  s_call_b64 s[54:55], L_kblock
  s_add_u32 s45, s44, 32768
  buffer_load_dwordx4 v[160:163], v18, s[40:43], s45 offen offset:0
  s_call_b64 s[54:55], L_kblock
  s_add_u32 s45, s44, 32768
  buffer_load_dwordx4 v[164:167], v18, s[40:43], s45 offen offset:1024
  s_add_u32 s45, s44, 32768
  buffer_load_dwordx4 v[168:171], v18, s[40:43], s45 offen offset:2048
  s_call_b64 s[54:55], L_kblock
  s_add_u32 s45, s44, 32768
  buffer_load_dwordx4 v[172:175], v18, s[40:43], s45 offen offset:3072
  s_call_b64 s[54:55], L_kblock
  s_add_u32 s45, s44, 36864
  buffer_load_dwordx4 v[176:179], v18, s[40:43], s45 offen offset:0
  s_add_u32 s45, s44, 36864
  buffer_load_dwordx4 v[180:183], v18, s[40:43], s45 offen offset:1024
  s_call_b64 s[54:55], L_kblock
  s_add_u32 s45, s44, 36864
  buffer_load_dwordx4 v[184:187], v18, s[40:43], s45 offen offset:2048
  s_call_b64 s[54:55], L_kblock
  s_add_u32 s45, s44, 36864
  buffer_load_dwordx4 v[188:191], v18, s[40:43], s45 offen offset:3072
  s_call_b64 s[54:55], L_kblock
  s_add_u32 s45, s44, 65536
  buffer_load_dwordx4 v[192:195], v18, s[40:43], s45 offen offset:0
  s_add_u32 s45, s44, 65536
  buffer_load_dwordx4 v[196:199], v18, s[40:43], s45 offen offset:1024
  s_call_b64 s[54:55], L_kblock
  s_add_u32 s45, s44, 65536
  buffer_load_dwordx4 v[200:203], v18, s[40:43], s45 offen offset:2048
  s_call_b64 s[54:55], L_kblock
  s_add_u32 s45, s44, 65536
  buffer_load_dwordx4 v[204:207], v18, s[40:43], s45 offen offset:3072
  s_add_u32 s45, s44, 69632
  buffer_load_dwordx4 v[208:211], v18, s[40:43], s45 offen offset:0
  s_call_b64 s[54:55], L_kblock
  ds_read_b32 v64, v16 offset:0
  ds_read_b32 v65, v16 offset:256
  ds_read_b32 v66, v16 offset:512
  ds_read_b32 v67, v16 offset:768
  ds_read_b32 v68, v16 offset:1024
  ds_read_b32 v69, v16 offset:1280
  ds_read_b32 v70, v16 offset:1536
  ds_read_b32 v71, v16 offset:1792
  ds_read_b32 v72, v16 offset:2048
  ds_read_b32 v73, v16 offset:2304
  ds_read_b32 v74, v16 offset:2560
  ds_read_b32 v75, v16 offset:2816
  ds_read_b32 v76, v16 offset:3072
  ds_read_b32 v77, v16 offset:3328
  ds_read_b32 v78, v16 offset:3584
  ds_read_b32 v79, v16 offset:3840
  s_nop 2
  v_max_f32_dpp v62, v62, v62 row_ror:8 row_mask:0xf bank_mask:0xf
  s_nop 2
  v_max_f32_dpp v62, v62, v62 row_ror:4 row_mask:0xf bank_mask:0xf
  s_nop 2
  v_max_f32_dpp v62, v62, v62 row_ror:2 row_mask:0xf bank_mask:0xf
  s_nop 2
  v_max_f32_dpp v62, v62, v62 row_ror:1 row_mask:0xf bank_mask:0xf
  v_mov_b32 v19, v62
  s_nop 1
  v_permlane16_swap_b32 v62, v19
  s_nop 1
  v_max_f32 v62, v62, v19
  v_mov_b32 v19, v62
  s_nop 1
  v_permlane32_swap_b32 v62, v19
  s_nop 1
  v_max_f32 v62, v62, v19
  s_mov_b32 s38, 0x3fb8aa3b
  v_mov_b32 v59, 0
  s_waitcnt lgkmcnt(0)
  v_sub_f32 v64, v64, v62
  v_sub_f32 v65, v65, v62
  v_sub_f32 v66, v66, v62
  v_sub_f32 v67, v67, v62
  v_sub_f32 v68, v68, v62
  v_sub_f32 v69, v69, v62
  v_sub_f32 v70, v70, v62
  v_sub_f32 v71, v71, v62
  v_sub_f32 v72, v72, v62
  v_sub_f32 v73, v73, v62
  v_sub_f32 v74, v74, v62
  v_sub_f32 v75, v75, v62
  v_sub_f32 v76, v76, v62
  v_sub_f32 v77, v77, v62
  v_sub_f32 v78, v78, v62
  v_sub_f32 v79, v79, v62
  v_mul_f32 v64, s38, v64
  v_mul_f32 v65, s38, v65
  v_mul_f32 v66, s38, v66
  v_mul_f32 v67, s38, v67
  v_mul_f32 v68, s38, v68
  v_mul_f32 v69, s38, v69
  v_mul_f32 v70, s38, v70
  v_mul_f32 v71, s38, v71
  v_mul_f32 v72, s38, v72
  v_mul_f32 v73, s38, v73
  v_mul_f32 v74, s38, v74
  v_mul_f32 v75, s38, v75
  v_mul_f32 v76, s38, v76
  v_mul_f32 v77, s38, v77
  v_mul_f32 v78, s38, v78
  v_mul_f32 v79, s38, v79
  v_exp_f32 v64, v64
  v_exp_f32 v65, v65
  v_exp_f32 v66, v66
  v_exp_f32 v67, v67
  v_exp_f32 v68, v68
  v_exp_f32 v69, v69
  v_exp_f32 v70, v70
  v_exp_f32 v71, v71
  v_exp_f32 v72, v72
  v_exp_f32 v73, v73
  v_exp_f32 v74, v74
  v_exp_f32 v75, v75
  v_exp_f32 v76, v76
  v_exp_f32 v77, v77
  v_exp_f32 v78, v78
  v_exp_f32 v79, v79
  s_nop 0
  v_add_f32 v59, v59, v64
  v_cvt_pk_bf16_f32 v64, v64, v64
  v_add_f32 v59, v59, v65
  v_cvt_pk_bf16_f32 v65, v65, v65
  v_add_f32 v59, v59, v66
  v_cvt_pk_bf16_f32 v66, v66, v66
  v_add_f32 v59, v59, v67
  v_cvt_pk_bf16_f32 v67, v67, v67
  v_add_f32 v59, v59, v68
  v_cvt_pk_bf16_f32 v68, v68, v68
  v_add_f32 v59, v59, v69
  v_cvt_pk_bf16_f32 v69, v69, v69
  v_add_f32 v59, v59, v70
  v_cvt_pk_bf16_f32 v70, v70, v70
  v_add_f32 v59, v59, v71
  v_cvt_pk_bf16_f32 v71, v71, v71
  v_add_f32 v59, v59, v72
  v_cvt_pk_bf16_f32 v72, v72, v72
  v_add_f32 v59, v59, v73
  v_cvt_pk_bf16_f32 v73, v73, v73
  v_add_f32 v59, v59, v74
  v_cvt_pk_bf16_f32 v74, v74, v74
  v_add_f32 v59, v59, v75
  v_cvt_pk_bf16_f32 v75, v75, v75
  v_add_f32 v59, v59, v76
  v_cvt_pk_bf16_f32 v76, v76, v76
  v_add_f32 v59, v59, v77
  v_cvt_pk_bf16_f32 v77, v77, v77
  v_add_f32 v59, v59, v78
  v_cvt_pk_bf16_f32 v78, v78, v78
  v_add_f32 v59, v59, v79
  v_cvt_pk_bf16_f32 v79, v79, v79
  ds_write_b32 v16, v64 offset:0
  ds_write_b32 v16, v65 offset:256
  ds_write_b32 v16, v66 offset:512
  ds_write_b32 v16, v67 offset:768
  ds_write_b32 v16, v68 offset:1024
  ds_write_b32 v16, v69 offset:1280
  ds_write_b32 v16, v70 offset:1536
  ds_write_b32 v16, v71 offset:1792
  ds_write_b32 v16, v72 offset:2048
  ds_write_b32 v16, v73 offset:2304
  ds_write_b32 v16, v74 offset:2560
  ds_write_b32 v16, v75 offset:2816
  ds_write_b32 v16, v76 offset:3072
  ds_write_b32 v16, v77 offset:3328
  ds_write_b32 v16, v78 offset:3584
  ds_write_b32 v16, v79 offset:3840
  s_nop 2
  v_add_f32_dpp v59, v59, v59 row_ror:8 row_mask:0xf bank_mask:0xf
  s_nop 2
  v_add_f32_dpp v59, v59, v59 row_ror:4 row_mask:0xf bank_mask:0xf
  s_nop 2
  v_add_f32_dpp v59, v59, v59 row_ror:2 row_mask:0xf bank_mask:0xf
  s_nop 2
  v_add_f32_dpp v59, v59, v59 row_ror:1 row_mask:0xf bank_mask:0xf
  v_mov_b32 v19, v59
  s_nop 1
  v_permlane16_swap_b32 v59, v19
  s_nop 1
  v_add_f32 v59, v59, v19
  v_mov_b32 v19, v59
  s_nop 1
  v_permlane32_swap_b32 v59, v19
  s_nop 1
  v_add_f32 v59, v59, v19
  v_mov_b32 v58, v62
  s_lshl_b32 s39, s35, 3
  s_add_u32 s39, s39, 132928
  v_mov_b32 v19, s39
  v_mov_b32 v56, 132608
  v_mov_b32 v57, 1
  s_mov_b64 exec, 1
  ds_write_b64 v19, v[58:59]
  ds_add_u32 v56, v57
  s_mov_b64 exec, -1
  s_lshl_b32 s38, s35, 12
  s_add_u32 s38, s38, 133120
  v_lshl_add_u32 v17, v3, 2, v2
  v_lshl_add_u32 v17, v17, 2, s38
  v_mov_b32 v36, 0
  v_mov_b32 v37, 0
  v_mov_b32 v38, 0
  v_mov_b32 v39, 0
  s_add_u32 s45, s44, 69632
  buffer_load_dwordx4 v[212:215], v18, s[40:43], s45 offen offset:1024
  s_call_b64 s[54:55], L_vblock
  s_add_u32 s45, s44, 69632
  buffer_load_dwordx4 v[216:219], v18, s[40:43], s45 offen offset:2048
  s_add_u32 s45, s44, 69632
  buffer_load_dwordx4 v[220:223], v18, s[40:43], s45 offen offset:3072
  s_call_b64 s[54:55], L_vblock
  s_add_u32 s45, s44, 98304
  buffer_load_dwordx4 v[224:227], v18, s[40:43], s45 offen offset:0
  s_call_b64 s[54:55], L_vblock
  s_add_u32 s45, s44, 98304
  buffer_load_dwordx4 v[228:231], v18, s[40:43], s45 offen offset:1024
  s_add_u32 s45, s44, 98304
  buffer_load_dwordx4 v[232:235], v18, s[40:43], s45 offen offset:2048
  s_call_b64 s[54:55], L_vblock
  s_add_u32 s45, s44, 98304
  buffer_load_dwordx4 v[236:239], v18, s[40:43], s45 offen offset:3072
  s_call_b64 s[54:55], L_vblock
L_mlwait:
  v_mov_b32 v56, 132608
  ds_read_b32 v19, v56
  s_waitcnt lgkmcnt(0)
  v_readfirstlane_b32 s38, v19
  s_sub_u32 s34, s34, 1
  s_cbranch_scc1 L_exit
  s_cmp_lt_u32 s38, 4
  s_cbranch_scc1 L_mlwait
  v_and_b32 v56, 3, v0
  v_lshlrev_b32 v56, 3, v56
  v_add_u32 v56, 132928, v56
  ds_read_b64 v[44:45], v56
  s_mov_b32 s38, 0x3fb8aa3b
  s_waitcnt lgkmcnt(0)
  v_max_f32_dpp v42, v44, v44 quad_perm:[1,0,3,2] row_mask:0xf bank_mask:0xf
  s_nop 1
  v_max_f32_dpp v42, v42, v42 quad_perm:[2,3,0,1] row_mask:0xf bank_mask:0xf
  v_sub_f32 v44, v44, v42
  v_mul_f32 v44, s38, v44
  v_exp_f32 v44, v44
  v_sub_f32 v41, v62, v42
  v_mul_f32 v43, v44, v45
  v_mul_f32 v41, s38, v41
  v_exp_f32 v41, v41
  v_add_f32_dpp v43, v43, v43 quad_perm:[1,0,3,2] row_mask:0xf bank_mask:0xf
  s_nop 1
  v_add_f32_dpp v43, v43, v43 quad_perm:[2,3,0,1] row_mask:0xf bank_mask:0xf
  v_rcp_f32 v44, v43
  s_nop 0
  v_mul_f32 v41, v41, v44
  v_min_u32 v42, -2, v42
  v_min_u32 v43, -2, v43
  v_mov_b32 v56, 132864
  v_mov_b32 v19, 1
  s_mov_b64 exec, 1
  ds_write_b64 v56, v[42:43] offset:128
  ds_write_b32 v56, v19
  s_mov_b64 exec, -1
  s_add_u32 s45, s44, 102400
  buffer_load_dwordx4 v[240:243], v18, s[40:43], s45 offen offset:0
  s_add_u32 s45, s44, 102400
  buffer_load_dwordx4 v[244:247], v18, s[40:43], s45 offen offset:1024
  s_call_b64 s[54:55], L_vblock
  s_add_u32 s45, s44, 102400
  buffer_load_dwordx4 v[248:251], v18, s[40:43], s45 offen offset:2048
  s_call_b64 s[54:55], L_vblock
  s_add_u32 s45, s44, 102400
  buffer_load_dwordx4 v[252:255], v18, s[40:43], s45 offen offset:3072
  s_call_b64 s[54:55], L_vblock
  s_call_b64 s[54:55], L_vblock
  s_call_b64 s[54:55], L_vblock
  s_call_b64 s[54:55], L_vblock
  s_waitcnt vmcnt(0)
  v_perm_b32 v20, v132, v128, s46
  v_perm_b32 v132, v132, v128, s47
  v_mov_b32 v128, v20
  v_perm_b32 v20, v133, v129, s46
  v_perm_b32 v21, v133, v129, s47
  v_perm_b32 v129, v140, v136, s46
  v_perm_b32 v133, v140, v136, s47
  v_mov_b32 v136, v20
  v_mov_b32 v140, v21
  v_perm_b32 v20, v134, v130, s46
  v_perm_b32 v21, v134, v130, s47
  v_perm_b32 v130, v148, v144, s46
  v_perm_b32 v134, v148, v144, s47
  v_mov_b32 v144, v20
  v_mov_b32 v148, v21
  v_perm_b32 v20, v135, v131, s46
  v_perm_b32 v21, v135, v131, s47
  v_perm_b32 v131, v156, v152, s46
  v_perm_b32 v135, v156, v152, s47
  v_mov_b32 v152, v20
  v_mov_b32 v156, v21
  v_perm_b32 v20, v141, v137, s46
  v_perm_b32 v141, v141, v137, s47
  v_mov_b32 v137, v20
  v_perm_b32 v20, v142, v138, s46
  v_perm_b32 v21, v142, v138, s47
  v_perm_b32 v138, v149, v145, s46
  v_perm_b32 v142, v149, v145, s47
  v_mov_b32 v145, v20
  v_mov_b32 v149, v21
  v_perm_b32 v20, v143, v139, s46
  v_perm_b32 v21, v143, v139, s47
  v_perm_b32 v139, v157, v153, s46
  v_perm_b32 v143, v157, v153, s47
  v_mov_b32 v153, v20
  v_mov_b32 v157, v21
  v_perm_b32 v20, v150, v146, s46
  v_perm_b32 v150, v150, v146, s47
  v_mov_b32 v146, v20
  v_perm_b32 v20, v151, v147, s46
  v_perm_b32 v21, v151, v147, s47
  v_perm_b32 v147, v158, v154, s46
  v_perm_b32 v151, v158, v154, s47
  v_mov_b32 v154, v20
  v_mov_b32 v158, v21
  v_perm_b32 v20, v159, v155, s46
  v_perm_b32 v159, v159, v155, s47
  v_mov_b32 v155, v20
  s_call_b64 s[54:55], L_vblock
  v_perm_b32 v20, v164, v160, s46
  v_perm_b32 v164, v164, v160, s47
  v_mov_b32 v160, v20
  v_perm_b32 v20, v165, v161, s46
  v_perm_b32 v21, v165, v161, s47
  v_perm_b32 v161, v172, v168, s46
  v_perm_b32 v165, v172, v168, s47
  v_mov_b32 v168, v20
  v_mov_b32 v172, v21
  v_perm_b32 v20, v166, v162, s46
  v_perm_b32 v21, v166, v162, s47
  v_perm_b32 v162, v180, v176, s46
  v_perm_b32 v166, v180, v176, s47
  v_mov_b32 v176, v20
  v_mov_b32 v180, v21
  v_perm_b32 v20, v167, v163, s46
  v_perm_b32 v21, v167, v163, s47
  v_perm_b32 v163, v188, v184, s46
  v_perm_b32 v167, v188, v184, s47
  v_mov_b32 v184, v20
  v_mov_b32 v188, v21
  v_perm_b32 v20, v173, v169, s46
  v_perm_b32 v173, v173, v169, s47
  v_mov_b32 v169, v20
  v_perm_b32 v20, v174, v170, s46
  v_perm_b32 v21, v174, v170, s47
  v_perm_b32 v170, v181, v177, s46
  v_perm_b32 v174, v181, v177, s47
  v_mov_b32 v177, v20
  v_mov_b32 v181, v21
  v_perm_b32 v20, v175, v171, s46
  v_perm_b32 v21, v175, v171, s47
  v_perm_b32 v171, v189, v185, s46
  v_perm_b32 v175, v189, v185, s47
  v_mov_b32 v185, v20
  v_mov_b32 v189, v21
  v_perm_b32 v20, v182, v178, s46
  v_perm_b32 v182, v182, v178, s47
  v_mov_b32 v178, v20
  v_perm_b32 v20, v183, v179, s46
  v_perm_b32 v21, v183, v179, s47
  v_perm_b32 v179, v190, v186, s46
  v_perm_b32 v183, v190, v186, s47
  v_mov_b32 v186, v20
  v_mov_b32 v190, v21
  v_perm_b32 v20, v191, v187, s46
  v_perm_b32 v191, v191, v187, s47
  v_mov_b32 v187, v20
  s_call_b64 s[54:55], L_vblock
  v_perm_b32 v20, v196, v192, s46
  v_perm_b32 v196, v196, v192, s47
  v_mov_b32 v192, v20
  v_perm_b32 v20, v197, v193, s46
  v_perm_b32 v21, v197, v193, s47
  v_perm_b32 v193, v204, v200, s46
  v_perm_b32 v197, v204, v200, s47
  v_mov_b32 v200, v20
  v_mov_b32 v204, v21
  v_perm_b32 v20, v198, v194, s46
  v_perm_b32 v21, v198, v194, s47
  v_perm_b32 v194, v212, v208, s46
  v_perm_b32 v198, v212, v208, s47
  v_mov_b32 v208, v20
  v_mov_b32 v212, v21
  v_perm_b32 v20, v199, v195, s46
  v_perm_b32 v21, v199, v195, s47
  v_perm_b32 v195, v220, v216, s46
  v_perm_b32 v199, v220, v216, s47
  v_mov_b32 v216, v20
  v_mov_b32 v220, v21
  v_perm_b32 v20, v205, v201, s46
  v_perm_b32 v205, v205, v201, s47
  v_mov_b32 v201, v20
  v_perm_b32 v20, v206, v202, s46
  v_perm_b32 v21, v206, v202, s47
  v_perm_b32 v202, v213, v209, s46
  v_perm_b32 v206, v213, v209, s47
  v_mov_b32 v209, v20
  v_mov_b32 v213, v21
  v_perm_b32 v20, v207, v203, s46
  v_perm_b32 v21, v207, v203, s47
  v_perm_b32 v203, v221, v217, s46
  v_perm_b32 v207, v221, v217, s47
  v_mov_b32 v217, v20
  v_mov_b32 v221, v21
  v_perm_b32 v20, v214, v210, s46
  v_perm_b32 v214, v214, v210, s47
  v_mov_b32 v210, v20
  v_perm_b32 v20, v215, v211, s46
  v_perm_b32 v21, v215, v211, s47
  v_perm_b32 v211, v222, v218, s46
  v_perm_b32 v215, v222, v218, s47
  v_mov_b32 v218, v20
  v_mov_b32 v222, v21
  v_perm_b32 v20, v223, v219, s46
  v_perm_b32 v223, v223, v219, s47
  v_mov_b32 v219, v20
  s_call_b64 s[54:55], L_vblock
  v_perm_b32 v20, v228, v224, s46
  v_perm_b32 v228, v228, v224, s47
  v_mov_b32 v224, v20
  v_perm_b32 v20, v229, v225, s46
  v_perm_b32 v21, v229, v225, s47
  v_perm_b32 v225, v236, v232, s46
  v_perm_b32 v229, v236, v232, s47
  v_mov_b32 v232, v20
  v_mov_b32 v236, v21
  v_perm_b32 v20, v230, v226, s46
  v_perm_b32 v21, v230, v226, s47
  v_perm_b32 v226, v244, v240, s46
  v_perm_b32 v230, v244, v240, s47
  v_mov_b32 v240, v20
  v_mov_b32 v244, v21
  v_perm_b32 v20, v231, v227, s46
  v_perm_b32 v21, v231, v227, s47
  v_perm_b32 v227, v252, v248, s46
  v_perm_b32 v231, v252, v248, s47
  v_mov_b32 v248, v20
  v_mov_b32 v252, v21
  v_perm_b32 v20, v237, v233, s46
  v_perm_b32 v237, v237, v233, s47
  v_mov_b32 v233, v20
  v_perm_b32 v20, v238, v234, s46
  v_perm_b32 v21, v238, v234, s47
  v_perm_b32 v234, v245, v241, s46
  v_perm_b32 v238, v245, v241, s47
  v_mov_b32 v241, v20
  v_mov_b32 v245, v21
  v_perm_b32 v20, v239, v235, s46
  v_perm_b32 v21, v239, v235, s47
  v_perm_b32 v235, v253, v249, s46
  v_perm_b32 v239, v253, v249, s47
  v_mov_b32 v249, v20
  v_mov_b32 v253, v21
  v_perm_b32 v20, v246, v242, s46
  v_perm_b32 v246, v246, v242, s47
  v_mov_b32 v242, v20
  v_perm_b32 v20, v247, v243, s46
  v_perm_b32 v21, v247, v243, s47
  v_perm_b32 v243, v254, v250, s46
  v_perm_b32 v247, v254, v250, s47
  v_mov_b32 v250, v20
  v_mov_b32 v254, v21
  v_perm_b32 v20, v255, v251, s46
  v_perm_b32 v255, v255, v251, s47
  v_mov_b32 v251, v20
  s_call_b64 s[54:55], L_vblock
  s_mul_i32 s38, s35, 576
  s_add_u32 s38, s38, 149504
  v_lshrrev_b32 v56, 1, v2
  v_mul_u32_u24 v56, 288, v56
  v_lshl_add_u32 v56, v3, 4, v56
  v_and_b32 v58, 1, v2
  v_lshl_add_u32 v56, v58, 3, v56
  v_add_u32 v56, s38, v56
  v_and_b32 v57, 7, v3
  v_mul_u32_u24 v57, 288, v57
  v_lshl_add_u32 v57, v2, 4, v57
  v_add_u32 v57, 149504, v57
  s_lshl_b32 s38, s33, 11
  s_lshl_b32 s39, s35, 9
  s_add_u32 s38, s38, s39
  v_lshlrev_b32 v58, 4, v58
  v_lshl_add_u32 v58, v3, 5, v58
  v_add_u32 v58, s38, v58
  s_mov_b32 s48, 0
  s_mov_b32 s49, -1
  ds_read_b32 v40, v17
  s_add_u32 s38, s36, 1
  s_cmp_eq_u32 s35, 3
  s_cselect_b32 s39, 1, 0
  s_waitcnt lgkmcnt(0)
  v_and_b32_dpp v80, v40, v4 row_newbcast:0 row_mask:0xf bank_mask:0xf
  v_and_b32_dpp v81, v40, v5 row_newbcast:0 row_mask:0xf bank_mask:0xf
  v_and_b32_dpp v82, v40, v6 row_newbcast:0 row_mask:0xf bank_mask:0xf
  v_and_b32_dpp v83, v40, v7 row_newbcast:0 row_mask:0xf bank_mask:0xf
  v_and_b32_dpp v84, v40, v4 row_newbcast:1 row_mask:0xf bank_mask:0xf
  v_and_b32_dpp v85, v40, v5 row_newbcast:1 row_mask:0xf bank_mask:0xf
  v_and_b32_dpp v86, v40, v6 row_newbcast:1 row_mask:0xf bank_mask:0xf
  v_and_b32_dpp v87, v40, v7 row_newbcast:1 row_mask:0xf bank_mask:0xf
  v_and_b32_dpp v88, v40, v4 row_newbcast:2 row_mask:0xf bank_mask:0xf
  v_and_b32_dpp v89, v40, v5 row_newbcast:2 row_mask:0xf bank_mask:0xf
  v_and_b32_dpp v90, v40, v6 row_newbcast:2 row_mask:0xf bank_mask:0xf
  v_and_b32_dpp v91, v40, v7 row_newbcast:2 row_mask:0xf bank_mask:0xf
  v_and_b32_dpp v92, v40, v4 row_newbcast:3 row_mask:0xf bank_mask:0xf
  v_and_b32_dpp v93, v40, v5 row_newbcast:3 row_mask:0xf bank_mask:0xf
  v_and_b32_dpp v94, v40, v6 row_newbcast:3 row_mask:0xf bank_mask:0xf
  v_and_b32_dpp v95, v40, v7 row_newbcast:3 row_mask:0xf bank_mask:0xf
  v_and_b32_dpp v96, v40, v4 row_newbcast:4 row_mask:0xf bank_mask:0xf
  v_and_b32_dpp v97, v40, v5 row_newbcast:4 row_mask:0xf bank_mask:0xf
  v_and_b32_dpp v98, v40, v6 row_newbcast:4 row_mask:0xf bank_mask:0xf
  v_and_b32_dpp v99, v40, v7 row_newbcast:4 row_mask:0xf bank_mask:0xf
  v_and_b32_dpp v100, v40, v4 row_newbcast:5 row_mask:0xf bank_mask:0xf
  v_and_b32_dpp v101, v40, v5 row_newbcast:5 row_mask:0xf bank_mask:0xf
  v_and_b32_dpp v102, v40, v6 row_newbcast:5 row_mask:0xf bank_mask:0xf
  v_and_b32_dpp v103, v40, v7 row_newbcast:5 row_mask:0xf bank_mask:0xf
  v_and_b32_dpp v104, v40, v4 row_newbcast:6 row_mask:0xf bank_mask:0xf
  v_and_b32_dpp v105, v40, v5 row_newbcast:6 row_mask:0xf bank_mask:0xf
  v_and_b32_dpp v106, v40, v6 row_newbcast:6 row_mask:0xf bank_mask:0xf
  v_and_b32_dpp v107, v40, v7 row_newbcast:6 row_mask:0xf bank_mask:0xf
  v_and_b32_dpp v108, v40, v4 row_newbcast:7 row_mask:0xf bank_mask:0xf
  v_and_b32_dpp v109, v40, v5 row_newbcast:7 row_mask:0xf bank_mask:0xf
  v_and_b32_dpp v110, v40, v6 row_newbcast:7 row_mask:0xf bank_mask:0xf
  v_and_b32_dpp v111, v40, v7 row_newbcast:7 row_mask:0xf bank_mask:0xf
  v_and_b32_dpp v112, v40, v4 row_newbcast:8 row_mask:0xf bank_mask:0xf
  v_and_b32_dpp v113, v40, v5 row_newbcast:8 row_mask:0xf bank_mask:0xf
  v_and_b32_dpp v114, v40, v6 row_newbcast:8 row_mask:0xf bank_mask:0xf
  v_and_b32_dpp v115, v40, v7 row_newbcast:8 row_mask:0xf bank_mask:0xf
  v_and_b32_dpp v116, v40, v4 row_newbcast:9 row_mask:0xf bank_mask:0xf
  v_and_b32_dpp v117, v40, v5 row_newbcast:9 row_mask:0xf bank_mask:0xf
  v_and_b32_dpp v118, v40, v6 row_newbcast:9 row_mask:0xf bank_mask:0xf
  v_and_b32_dpp v119, v40, v7 row_newbcast:9 row_mask:0xf bank_mask:0xf
  v_and_b32_dpp v120, v40, v4 row_newbcast:10 row_mask:0xf bank_mask:0xf
  v_and_b32_dpp v121, v40, v5 row_newbcast:10 row_mask:0xf bank_mask:0xf
  v_and_b32_dpp v122, v40, v6 row_newbcast:10 row_mask:0xf bank_mask:0xf
  v_and_b32_dpp v123, v40, v7 row_newbcast:10 row_mask:0xf bank_mask:0xf
  v_and_b32_dpp v124, v40, v4 row_newbcast:11 row_mask:0xf bank_mask:0xf
  v_and_b32_dpp v125, v40, v5 row_newbcast:11 row_mask:0xf bank_mask:0xf
  v_and_b32_dpp v126, v40, v6 row_newbcast:11 row_mask:0xf bank_mask:0xf
  v_and_b32_dpp v127, v40, v7 row_newbcast:11 row_mask:0xf bank_mask:0xf
  v_and_b32_dpp v20, v40, v4 row_newbcast:12 row_mask:0xf bank_mask:0xf
  v_and_b32_dpp v21, v40, v5 row_newbcast:12 row_mask:0xf bank_mask:0xf
  v_and_b32_dpp v22, v40, v6 row_newbcast:12 row_mask:0xf bank_mask:0xf
  v_and_b32_dpp v23, v40, v7 row_newbcast:12 row_mask:0xf bank_mask:0xf
  v_and_b32_dpp v24, v40, v4 row_newbcast:13 row_mask:0xf bank_mask:0xf
  v_and_b32_dpp v25, v40, v5 row_newbcast:13 row_mask:0xf bank_mask:0xf
  v_and_b32_dpp v26, v40, v6 row_newbcast:13 row_mask:0xf bank_mask:0xf
  v_and_b32_dpp v27, v40, v7 row_newbcast:13 row_mask:0xf bank_mask:0xf
  v_and_b32_dpp v28, v40, v4 row_newbcast:14 row_mask:0xf bank_mask:0xf
  v_and_b32_dpp v29, v40, v5 row_newbcast:14 row_mask:0xf bank_mask:0xf
  v_and_b32_dpp v30, v40, v6 row_newbcast:14 row_mask:0xf bank_mask:0xf
  v_and_b32_dpp v31, v40, v7 row_newbcast:14 row_mask:0xf bank_mask:0xf
  v_and_b32_dpp v32, v40, v4 row_newbcast:15 row_mask:0xf bank_mask:0xf
  v_and_b32_dpp v33, v40, v5 row_newbcast:15 row_mask:0xf bank_mask:0xf
  v_and_b32_dpp v34, v40, v6 row_newbcast:15 row_mask:0xf bank_mask:0xf
  v_and_b32_dpp v35, v40, v7 row_newbcast:15 row_mask:0xf bank_mask:0xf
L_lq0:
  ds_read_b32 v19, v61
  s_waitcnt lgkmcnt(0)
  v_readfirstlane_b32 s36, v19
  s_sub_u32 s34, s34, 1
  s_cbranch_scc1 L_exit
  s_cmp_lt_i32 s36, s38
  s_cbranch_scc1 L_lq0
  ds_read_b128 v[64:67], v60 offset:0
  ds_read_b128 v[68:71], v60 offset:1024
  ds_read_b128 v[72:75], v60 offset:2048
  ds_read_b128 v[76:79], v60 offset:3072
  s_add_u32 s38, s38, s39
  s_waitcnt lgkmcnt(3)
  v_mfma_f32_16x16x32_bf16 v[36:39], v[80:83], v[64:67], v[36:39]
  s_waitcnt lgkmcnt(2)
  v_mfma_f32_16x16x32_bf16 v[36:39], v[84:87], v[68:71], v[36:39]
  s_waitcnt lgkmcnt(1)
  v_mfma_f32_16x16x32_bf16 v[36:39], v[88:91], v[72:75], v[36:39]
  s_waitcnt lgkmcnt(0)
  v_mfma_f32_16x16x32_bf16 v[36:39], v[92:95], v[76:79], v[36:39]
L_lq1:
  ds_read_b32 v19, v61
  s_waitcnt lgkmcnt(0)
  v_readfirstlane_b32 s36, v19
  s_sub_u32 s34, s34, 1
  s_cbranch_scc1 L_exit
  s_cmp_lt_i32 s36, s38
  s_cbranch_scc1 L_lq1
  ds_read_b128 v[64:67], v60 offset:4096
  ds_read_b128 v[68:71], v60 offset:5120
  ds_read_b128 v[72:75], v60 offset:6144
  ds_read_b128 v[76:79], v60 offset:7168
  s_add_u32 s38, s38, s39
  s_waitcnt lgkmcnt(3)
  v_mfma_f32_16x16x32_bf16 v[36:39], v[96:99], v[64:67], v[36:39]
  s_waitcnt lgkmcnt(2)
  v_mfma_f32_16x16x32_bf16 v[36:39], v[100:103], v[68:71], v[36:39]
  s_waitcnt lgkmcnt(1)
  v_mfma_f32_16x16x32_bf16 v[36:39], v[104:107], v[72:75], v[36:39]
  s_waitcnt lgkmcnt(0)
  v_mfma_f32_16x16x32_bf16 v[36:39], v[108:111], v[76:79], v[36:39]
L_lq2:
  ds_read_b32 v19, v61
  s_waitcnt lgkmcnt(0)
  v_readfirstlane_b32 s36, v19
  s_sub_u32 s34, s34, 1
  s_cbranch_scc1 L_exit
  s_cmp_lt_i32 s36, s38
  s_cbranch_scc1 L_lq2
  ds_read_b128 v[64:67], v60 offset:8192
  ds_read_b128 v[68:71], v60 offset:9216
  ds_read_b128 v[72:75], v60 offset:10240
  ds_read_b128 v[76:79], v60 offset:11264
  s_add_u32 s38, s38, s39
  s_waitcnt lgkmcnt(3)
  v_mfma_f32_16x16x32_bf16 v[36:39], v[112:115], v[64:67], v[36:39]
  s_waitcnt lgkmcnt(2)
  v_mfma_f32_16x16x32_bf16 v[36:39], v[116:119], v[68:71], v[36:39]
  s_waitcnt lgkmcnt(1)
  v_mfma_f32_16x16x32_bf16 v[36:39], v[120:123], v[72:75], v[36:39]
  s_waitcnt lgkmcnt(0)
  v_mfma_f32_16x16x32_bf16 v[36:39], v[124:127], v[76:79], v[36:39]
L_lq3:
  ds_read_b32 v19, v61
  s_waitcnt lgkmcnt(0)
  v_readfirstlane_b32 s36, v19
  s_sub_u32 s34, s34, 1
  s_cbranch_scc1 L_exit
  s_cmp_lt_i32 s36, s38
  s_cbranch_scc1 L_lq3
  ds_read_b128 v[64:67], v60 offset:12288
  ds_read_b128 v[68:71], v60 offset:13312
  ds_read_b128 v[72:75], v60 offset:14336
  ds_read_b128 v[76:79], v60 offset:15360
  s_add_u32 s38, s38, s39
  s_waitcnt lgkmcnt(3)
  v_mfma_f32_16x16x32_bf16 v[36:39], v[20:23], v[64:67], v[36:39]
  s_waitcnt lgkmcnt(2)
  v_mfma_f32_16x16x32_bf16 v[36:39], v[24:27], v[68:71], v[36:39]
  s_waitcnt lgkmcnt(1)
  v_mfma_f32_16x16x32_bf16 v[36:39], v[28:31], v[72:75], v[36:39]
  s_waitcnt lgkmcnt(0)
  v_mfma_f32_16x16x32_bf16 v[36:39], v[32:35], v[76:79], v[36:39]
  s_nop 0
  s_nop 6
  v_mul_f32 v36, v36, v41
  v_mul_f32 v37, v37, v41
  v_mul_f32 v38, v38, v41
  v_mul_f32 v39, v39, v41
  v_cvt_pk_bf16_f32 v44, v36, v37
  v_cvt_pk_bf16_f32 v45, v38, v39
  v_lshlrev_b32 v46, 16, v44
  v_and_b32 v47, 0xffff0000, v44
  v_lshlrev_b32 v48, 16, v45
  v_and_b32 v49, 0xffff0000, v45
  v_sub_f32 v36, v36, v46
  v_sub_f32 v37, v37, v47
  v_sub_f32 v38, v38, v48
  v_sub_f32 v39, v39, v49
  v_cvt_pk_bf16_f32 v46, v36, v37
  v_cvt_pk_bf16_f32 v47, v38, v39
  v_cndmask_b32 v44, v44, v46, s[48:49]
  v_cndmask_b32 v45, v45, v47, s[48:49]
  ds_write_b64 v56, v[44:45]
  s_waitcnt lgkmcnt(0)
  s_barrier
  ds_read_b128 v[20:23], v57 offset:0
  ds_read_b128 v[24:27], v57 offset:64
  ds_read_b128 v[28:31], v57 offset:128
  ds_read_b128 v[32:35], v57 offset:192
  s_waitcnt lgkmcnt(3)
  v_mfma_f32_16x16x32_bf16 v[64:67], v[20:23], v[128:131], 0
  s_waitcnt lgkmcnt(2)
  v_mfma_f32_16x16x32_bf16 v[64:67], v[24:27], v[160:163], v[64:67]
  s_waitcnt lgkmcnt(1)
  v_mfma_f32_16x16x32_bf16 v[64:67], v[28:31], v[192:195], v[64:67]
  s_waitcnt lgkmcnt(0)
  v_mfma_f32_16x16x32_bf16 v[64:67], v[32:35], v[224:227], v[64:67]
  v_mfma_f32_16x16x32_bf16 v[68:71], v[20:23], v[132:135], 0
  v_mfma_f32_16x16x32_bf16 v[68:71], v[24:27], v[164:167], v[68:71]
  v_mfma_f32_16x16x32_bf16 v[68:71], v[28:31], v[196:199], v[68:71]
  v_mfma_f32_16x16x32_bf16 v[68:71], v[32:35], v[228:231], v[68:71]
  v_mfma_f32_16x16x32_bf16 v[72:75], v[20:23], v[136:139], 0
  v_mfma_f32_16x16x32_bf16 v[72:75], v[24:27], v[168:171], v[72:75]
  v_mfma_f32_16x16x32_bf16 v[72:75], v[28:31], v[200:203], v[72:75]
  v_mfma_f32_16x16x32_bf16 v[72:75], v[32:35], v[232:235], v[72:75]
  v_mfma_f32_16x16x32_bf16 v[76:79], v[20:23], v[140:143], 0
  v_mfma_f32_16x16x32_bf16 v[76:79], v[24:27], v[172:175], v[76:79]
  v_add_f32 v64, v64, v65
  v_mfma_f32_16x16x32_bf16 v[76:79], v[28:31], v[204:207], v[76:79]
  v_add_f32 v66, v66, v67
  v_mfma_f32_16x16x32_bf16 v[76:79], v[32:35], v[236:239], v[76:79]
  v_add_f32 v96, v64, v66
  v_mfma_f32_16x16x32_bf16 v[80:83], v[20:23], v[144:147], 0
  v_mfma_f32_16x16x32_bf16 v[80:83], v[24:27], v[176:179], v[80:83]
  v_add_f32 v68, v68, v69
  v_mfma_f32_16x16x32_bf16 v[80:83], v[28:31], v[208:211], v[80:83]
  v_add_f32 v70, v70, v71
  v_mfma_f32_16x16x32_bf16 v[80:83], v[32:35], v[240:243], v[80:83]
  v_add_f32 v97, v68, v70
  v_mfma_f32_16x16x32_bf16 v[84:87], v[20:23], v[148:151], 0
  v_mfma_f32_16x16x32_bf16 v[84:87], v[24:27], v[180:183], v[84:87]
  v_add_f32 v72, v72, v73
  v_mfma_f32_16x16x32_bf16 v[84:87], v[28:31], v[212:215], v[84:87]
  v_add_f32 v74, v74, v75
  v_mfma_f32_16x16x32_bf16 v[84:87], v[32:35], v[244:247], v[84:87]
  v_add_f32 v98, v72, v74
  v_mfma_f32_16x16x32_bf16 v[88:91], v[20:23], v[152:155], 0
  v_mfma_f32_16x16x32_bf16 v[88:91], v[24:27], v[184:187], v[88:91]
  v_add_f32 v76, v76, v77
  v_mfma_f32_16x16x32_bf16 v[88:91], v[28:31], v[216:219], v[88:91]
  v_add_f32 v78, v78, v79
  v_mfma_f32_16x16x32_bf16 v[88:91], v[32:35], v[248:251], v[88:91]
  v_add_f32 v99, v76, v78
  v_mfma_f32_16x16x32_bf16 v[92:95], v[20:23], v[156:159], 0
  v_mfma_f32_16x16x32_bf16 v[92:95], v[24:27], v[188:191], v[92:95]
  v_add_f32 v80, v80, v81
  v_mfma_f32_16x16x32_bf16 v[92:95], v[28:31], v[220:223], v[92:95]
  v_add_f32 v82, v82, v83
  v_mfma_f32_16x16x32_bf16 v[92:95], v[32:35], v[252:255], v[92:95]
  v_add_f32 v100, v80, v82
  v_add_f32 v84, v84, v85
  v_add_f32 v86, v86, v87
  v_add_f32 v101, v84, v86
  v_add_f32 v88, v88, v89
  v_add_f32 v90, v90, v91
  v_add_f32 v102, v88, v90
  s_nop 0
  v_add_f32 v92, v92, v93
  v_add_f32 v94, v94, v95
  v_add_f32 v103, v92, v94
  s_nop 1
  v_permlane16_swap_b32 v96, v100
  v_permlane16_swap_b32 v97, v101
  v_permlane16_swap_b32 v98, v102
  v_permlane16_swap_b32 v99, v103
  s_nop 1
  v_add_f32 v96, v96, v100
  v_add_f32 v97, v97, v101
  v_add_f32 v98, v98, v102
  v_add_f32 v99, v99, v103
  v_min_u32 v96, -2, v96
  v_min_u32 v97, -2, v97
  v_min_u32 v98, -2, v98
  v_min_u32 v99, -2, v99
  s_mov_b32 exec_hi, 0
  global_store_dwordx4 v58, v[96:99], s[26:27] sc1
  s_mov_b64 exec, -1
  s_endpgm
L_kblock:
  ds_read_b32 v19, v61
  s_waitcnt lgkmcnt(0)
  v_readfirstlane_b32 s38, v19
  s_cmp_gt_i32 s38, s36
  s_cbranch_scc1 L_go_k
  s_sub_u32 s34, s34, 1
  s_cbranch_scc1 L_exit
  s_sleep 1
  s_branch L_kblock
L_go_k:
  s_add_u32 s37, s37, 1
  v_mov_b32 v19, s37
  ds_read_b128 v[64:67], v52 offset:0
  ds_read_b128 v[68:71], v53 offset:0
  ds_read_b128 v[72:75], v54 offset:0
  ds_read_b128 v[76:79], v55 offset:0
  ds_read_b128 v[80:83], v52 offset:4096
  ds_read_b128 v[84:87], v53 offset:4096
  ds_read_b128 v[88:91], v54 offset:4096
  ds_read_b128 v[92:95], v55 offset:4096
  ds_read_b128 v[96:99], v52 offset:8192
  ds_read_b128 v[100:103], v53 offset:8192
  ds_read_b128 v[104:107], v54 offset:8192
  ds_read_b128 v[108:111], v55 offset:8192
  ds_read_b128 v[112:115], v52 offset:12288
  ds_read_b128 v[116:119], v53 offset:12288
  ds_read_b128 v[120:123], v54 offset:12288
  ds_read_b128 v[124:127], v55 offset:12288
  ds_write_b32 v1, v19
  v_xor_b32 v52, 0x10000, v52
  v_xor_b32 v53, 0x10000, v53
  v_xor_b32 v54, 0x10000, v54
  v_xor_b32 v55, 0x10000, v55
L_kmf:
  s_waitcnt lgkmcnt(15)
  v_mfma_f32_16x16x32_bf16 v[36:39], v[20:23], v[64:67], 0
  s_waitcnt lgkmcnt(15)
  v_mfma_f32_16x16x32_bf16 v[36:39], v[24:27], v[68:71], v[36:39]
  s_waitcnt lgkmcnt(14)
  v_mfma_f32_16x16x32_bf16 v[36:39], v[28:31], v[72:75], v[36:39]
  s_waitcnt lgkmcnt(13)
  v_mfma_f32_16x16x32_bf16 v[36:39], v[32:35], v[76:79], v[36:39]
  s_waitcnt lgkmcnt(12)
  v_mfma_f32_16x16x32_bf16 v[40:43], v[20:23], v[80:83], 0
  s_waitcnt lgkmcnt(11)
  v_mfma_f32_16x16x32_bf16 v[40:43], v[24:27], v[84:87], v[40:43]
  s_waitcnt lgkmcnt(10)
  v_mfma_f32_16x16x32_bf16 v[40:43], v[28:31], v[88:91], v[40:43]
  s_waitcnt lgkmcnt(9)
  v_mfma_f32_16x16x32_bf16 v[40:43], v[32:35], v[92:95], v[40:43]
  s_waitcnt lgkmcnt(8)
  v_mfma_f32_16x16x32_bf16 v[44:47], v[20:23], v[96:99], 0
  s_waitcnt lgkmcnt(7)
  v_mfma_f32_16x16x32_bf16 v[44:47], v[24:27], v[100:103], v[44:47]
  s_waitcnt lgkmcnt(6)
  v_mfma_f32_16x16x32_bf16 v[44:47], v[28:31], v[104:107], v[44:47]
  s_waitcnt lgkmcnt(5)
  v_mfma_f32_16x16x32_bf16 v[44:47], v[32:35], v[108:111], v[44:47]
  s_waitcnt lgkmcnt(4)
  v_mfma_f32_16x16x32_bf16 v[48:51], v[20:23], v[112:115], 0
  s_waitcnt lgkmcnt(3)
  v_mfma_f32_16x16x32_bf16 v[48:51], v[24:27], v[116:119], v[48:51]
  s_waitcnt lgkmcnt(2)
  v_mfma_f32_16x16x32_bf16 v[48:51], v[28:31], v[120:123], v[48:51]
  s_waitcnt lgkmcnt(1)
  v_mfma_f32_16x16x32_bf16 v[48:51], v[32:35], v[124:127], v[48:51]
  v_mov_b32 v19, v36
  v_mov_b32_dpp v19, v40 quad_perm:[0,1,2,3] row_mask:0x2 bank_mask:0xf
  v_mov_b32_dpp v19, v44 quad_perm:[0,1,2,3] row_mask:0x4 bank_mask:0xf
  s_add_u32 s36, s36, 4
  s_nop 4
  v_mov_b32_dpp v19, v48 quad_perm:[0,1,2,3] row_mask:0x8 bank_mask:0xf
  v_cvt_pk_bf16_f32 v19, v19, v19
  v_and_b32 v19, 0xffff0000, v19
  v_mul_f32 v19, 0x3db504f3, v19
  v_cvt_pk_bf16_f32 v19, v19, v19
  v_and_b32 v19, 0xffff0000, v19
  v_max_f32 v62, v62, v19
  ds_write_b32 v17, v19
  v_add_u32 v17, 0x100, v17
  s_setpc_b64 s[54:55]
L_vblock:
  ds_read_b32 v19, v61
  s_waitcnt lgkmcnt(0)
  v_readfirstlane_b32 s38, v19
  s_cmp_gt_i32 s38, s36
  s_cbranch_scc1 L_go_v
  s_sub_u32 s34, s34, 1
  s_cbranch_scc1 L_exit
  s_sleep 1
  s_branch L_vblock
L_go_v:
  s_add_u32 s37, s37, 1
  v_mov_b32 v19, s37
  ds_read_b32 v40, v17
  ds_read_b128 v[64:67], v60 offset:0
  ds_read_b128 v[68:71], v60 offset:1024
  ds_read_b128 v[72:75], v60 offset:2048
  ds_read_b128 v[76:79], v60 offset:3072
  ds_read_b128 v[80:83], v60 offset:4096
  ds_read_b128 v[84:87], v60 offset:5120
  ds_read_b128 v[88:91], v60 offset:6144
  ds_read_b128 v[92:95], v60 offset:7168
  ds_read_b128 v[96:99], v60 offset:8192
  ds_read_b128 v[100:103], v60 offset:9216
  ds_read_b128 v[104:107], v60 offset:10240
  ds_read_b128 v[108:111], v60 offset:11264
  ds_read_b128 v[112:115], v60 offset:12288
  ds_read_b128 v[116:119], v60 offset:13312
  ds_read_b128 v[120:123], v60 offset:14336
  ds_read_b128 v[124:127], v60 offset:15360
  ds_write_b32 v1, v19
  v_add_u32 v17, 0x100, v17
  v_xor_b32 v60, 0x10000, v60
  s_add_u32 s36, s36, 4
  s_waitcnt lgkmcnt(15)
  v_and_b32_dpp v8, v40, v4 row_newbcast:0 row_mask:0xf bank_mask:0xf
  v_and_b32_dpp v9, v40, v5 row_newbcast:0 row_mask:0xf bank_mask:0xf
  v_and_b32_dpp v10, v40, v6 row_newbcast:0 row_mask:0xf bank_mask:0xf
  v_and_b32_dpp v11, v40, v7 row_newbcast:0 row_mask:0xf bank_mask:0xf
  v_and_b32_dpp v12, v40, v4 row_newbcast:1 row_mask:0xf bank_mask:0xf
  v_and_b32_dpp v13, v40, v5 row_newbcast:1 row_mask:0xf bank_mask:0xf
  v_and_b32_dpp v14, v40, v6 row_newbcast:1 row_mask:0xf bank_mask:0xf
  v_and_b32_dpp v15, v40, v7 row_newbcast:1 row_mask:0xf bank_mask:0xf
  s_waitcnt lgkmcnt(15)
  v_mfma_f32_16x16x32_bf16 v[36:39], v[8:11], v[64:67], v[36:39]
  v_and_b32_dpp v8, v40, v4 row_newbcast:2 row_mask:0xf bank_mask:0xf
  v_and_b32_dpp v9, v40, v5 row_newbcast:2 row_mask:0xf bank_mask:0xf
  v_and_b32_dpp v10, v40, v6 row_newbcast:2 row_mask:0xf bank_mask:0xf
  v_and_b32_dpp v11, v40, v7 row_newbcast:2 row_mask:0xf bank_mask:0xf
  s_waitcnt lgkmcnt(15)
  v_mfma_f32_16x16x32_bf16 v[36:39], v[12:15], v[68:71], v[36:39]
  v_and_b32_dpp v12, v40, v4 row_newbcast:3 row_mask:0xf bank_mask:0xf
  v_and_b32_dpp v13, v40, v5 row_newbcast:3 row_mask:0xf bank_mask:0xf
  v_and_b32_dpp v14, v40, v6 row_newbcast:3 row_mask:0xf bank_mask:0xf
  v_and_b32_dpp v15, v40, v7 row_newbcast:3 row_mask:0xf bank_mask:0xf
  s_waitcnt lgkmcnt(14)
  v_mfma_f32_16x16x32_bf16 v[36:39], v[8:11], v[72:75], v[36:39]
  v_and_b32_dpp v8, v40, v4 row_newbcast:4 row_mask:0xf bank_mask:0xf
  v_and_b32_dpp v9, v40, v5 row_newbcast:4 row_mask:0xf bank_mask:0xf
  v_and_b32_dpp v10, v40, v6 row_newbcast:4 row_mask:0xf bank_mask:0xf
  v_and_b32_dpp v11, v40, v7 row_newbcast:4 row_mask:0xf bank_mask:0xf
  s_waitcnt lgkmcnt(13)
  v_mfma_f32_16x16x32_bf16 v[36:39], v[12:15], v[76:79], v[36:39]
  v_and_b32_dpp v12, v40, v4 row_newbcast:5 row_mask:0xf bank_mask:0xf
  v_and_b32_dpp v13, v40, v5 row_newbcast:5 row_mask:0xf bank_mask:0xf
  v_and_b32_dpp v14, v40, v6 row_newbcast:5 row_mask:0xf bank_mask:0xf
  v_and_b32_dpp v15, v40, v7 row_newbcast:5 row_mask:0xf bank_mask:0xf
  s_waitcnt lgkmcnt(12)
  v_mfma_f32_16x16x32_bf16 v[36:39], v[8:11], v[80:83], v[36:39]
  v_and_b32_dpp v8, v40, v4 row_newbcast:6 row_mask:0xf bank_mask:0xf
  v_and_b32_dpp v9, v40, v5 row_newbcast:6 row_mask:0xf bank_mask:0xf
  v_and_b32_dpp v10, v40, v6 row_newbcast:6 row_mask:0xf bank_mask:0xf
  v_and_b32_dpp v11, v40, v7 row_newbcast:6 row_mask:0xf bank_mask:0xf
  s_waitcnt lgkmcnt(11)
  v_mfma_f32_16x16x32_bf16 v[36:39], v[12:15], v[84:87], v[36:39]
  v_and_b32_dpp v12, v40, v4 row_newbcast:7 row_mask:0xf bank_mask:0xf
  v_and_b32_dpp v13, v40, v5 row_newbcast:7 row_mask:0xf bank_mask:0xf
  v_and_b32_dpp v14, v40, v6 row_newbcast:7 row_mask:0xf bank_mask:0xf
  v_and_b32_dpp v15, v40, v7 row_newbcast:7 row_mask:0xf bank_mask:0xf
  s_waitcnt lgkmcnt(10)
  v_mfma_f32_16x16x32_bf16 v[36:39], v[8:11], v[88:91], v[36:39]
  v_and_b32_dpp v8, v40, v4 row_newbcast:8 row_mask:0xf bank_mask:0xf
  v_and_b32_dpp v9, v40, v5 row_newbcast:8 row_mask:0xf bank_mask:0xf
  v_and_b32_dpp v10, v40, v6 row_newbcast:8 row_mask:0xf bank_mask:0xf
  v_and_b32_dpp v11, v40, v7 row_newbcast:8 row_mask:0xf bank_mask:0xf
  s_waitcnt lgkmcnt(9)
  v_mfma_f32_16x16x32_bf16 v[36:39], v[12:15], v[92:95], v[36:39]
  v_and_b32_dpp v12, v40, v4 row_newbcast:9 row_mask:0xf bank_mask:0xf
  v_and_b32_dpp v13, v40, v5 row_newbcast:9 row_mask:0xf bank_mask:0xf
  v_and_b32_dpp v14, v40, v6 row_newbcast:9 row_mask:0xf bank_mask:0xf
  v_and_b32_dpp v15, v40, v7 row_newbcast:9 row_mask:0xf bank_mask:0xf
  s_waitcnt lgkmcnt(8)
  v_mfma_f32_16x16x32_bf16 v[36:39], v[8:11], v[96:99], v[36:39]
  v_and_b32_dpp v8, v40, v4 row_newbcast:10 row_mask:0xf bank_mask:0xf
  v_and_b32_dpp v9, v40, v5 row_newbcast:10 row_mask:0xf bank_mask:0xf
  v_and_b32_dpp v10, v40, v6 row_newbcast:10 row_mask:0xf bank_mask:0xf
  v_and_b32_dpp v11, v40, v7 row_newbcast:10 row_mask:0xf bank_mask:0xf
  s_waitcnt lgkmcnt(7)
  v_mfma_f32_16x16x32_bf16 v[36:39], v[12:15], v[100:103], v[36:39]
  v_and_b32_dpp v12, v40, v4 row_newbcast:11 row_mask:0xf bank_mask:0xf
  v_and_b32_dpp v13, v40, v5 row_newbcast:11 row_mask:0xf bank_mask:0xf
  v_and_b32_dpp v14, v40, v6 row_newbcast:11 row_mask:0xf bank_mask:0xf
  v_and_b32_dpp v15, v40, v7 row_newbcast:11 row_mask:0xf bank_mask:0xf
  s_waitcnt lgkmcnt(6)
  v_mfma_f32_16x16x32_bf16 v[36:39], v[8:11], v[104:107], v[36:39]
  v_and_b32_dpp v8, v40, v4 row_newbcast:12 row_mask:0xf bank_mask:0xf
  v_and_b32_dpp v9, v40, v5 row_newbcast:12 row_mask:0xf bank_mask:0xf
  v_and_b32_dpp v10, v40, v6 row_newbcast:12 row_mask:0xf bank_mask:0xf
  v_and_b32_dpp v11, v40, v7 row_newbcast:12 row_mask:0xf bank_mask:0xf
  s_waitcnt lgkmcnt(5)
  v_mfma_f32_16x16x32_bf16 v[36:39], v[12:15], v[108:111], v[36:39]
  v_and_b32_dpp v12, v40, v4 row_newbcast:13 row_mask:0xf bank_mask:0xf
  v_and_b32_dpp v13, v40, v5 row_newbcast:13 row_mask:0xf bank_mask:0xf
  v_and_b32_dpp v14, v40, v6 row_newbcast:13 row_mask:0xf bank_mask:0xf
  v_and_b32_dpp v15, v40, v7 row_newbcast:13 row_mask:0xf bank_mask:0xf
  s_waitcnt lgkmcnt(4)
  v_mfma_f32_16x16x32_bf16 v[36:39], v[8:11], v[112:115], v[36:39]
  v_and_b32_dpp v8, v40, v4 row_newbcast:14 row_mask:0xf bank_mask:0xf
  v_and_b32_dpp v9, v40, v5 row_newbcast:14 row_mask:0xf bank_mask:0xf
  v_and_b32_dpp v10, v40, v6 row_newbcast:14 row_mask:0xf bank_mask:0xf
  v_and_b32_dpp v11, v40, v7 row_newbcast:14 row_mask:0xf bank_mask:0xf
  s_waitcnt lgkmcnt(3)
  v_mfma_f32_16x16x32_bf16 v[36:39], v[12:15], v[116:119], v[36:39]
  v_and_b32_dpp v12, v40, v4 row_newbcast:15 row_mask:0xf bank_mask:0xf
  v_and_b32_dpp v13, v40, v5 row_newbcast:15 row_mask:0xf bank_mask:0xf
  v_and_b32_dpp v14, v40, v6 row_newbcast:15 row_mask:0xf bank_mask:0xf
  v_and_b32_dpp v15, v40, v7 row_newbcast:15 row_mask:0xf bank_mask:0xf
  s_waitcnt lgkmcnt(2)
  v_mfma_f32_16x16x32_bf16 v[36:39], v[8:11], v[120:123], v[36:39]
  s_nop 1
  s_waitcnt lgkmcnt(1)
  v_mfma_f32_16x16x32_bf16 v[36:39], v[12:15], v[124:127], v[36:39]
  s_setpc_b64 s[54:55]
L_side:
  v_lshlrev_b32 v1, 4, v0
  s_lshl_b32 s37, s33, 7
  s_add_u32 s37, s37, 524288
  v_add_u32 v59, s37, v1
  s_lshl_b32 s37, s33, 11
  v_add_u32 v58, s37, v1
  s_sub_u32 s40, s2, 14
  s_lshl_b32 s37, s40, 13
  s_add_u32 s37, s37, 524288
  v_add_u32 v60, s37, v1
  v_add_u32 v61, 0x1000, v60
  v_mov_b32 v8, -1
  v_mov_b32 v9, -1
  v_mov_b32 v10, -1
  v_mov_b32 v11, -1
  s_lshl_b32 s37, s40, 2
  v_mov_b32 v14, s37
  v_mov_b32 v15, 1
  s_mov_b32 s52, 6
  s_waitcnt lgkmcnt(0)
  global_store_dwordx4 v58, v[8:11], s[26:27] sc1
  global_store_dwordx4 v58, v[8:11], s[26:27] offset:1024 sc1
  s_cmp_ge_u32 s40, 4
  s_cbranch_scc1 L_nojan
  global_store_dwordx4 v60, v[8:11], s[26:27] offset:0 sc1
  global_store_dwordx4 v61, v[8:11], s[26:27] offset:0 sc1
  global_store_dwordx4 v60, v[8:11], s[26:27] offset:1024 sc1
  global_store_dwordx4 v61, v[8:11], s[26:27] offset:1024 sc1
  global_store_dwordx4 v60, v[8:11], s[26:27] offset:2048 sc1
  global_store_dwordx4 v61, v[8:11], s[26:27] offset:2048 sc1
  global_store_dwordx4 v60, v[8:11], s[26:27] offset:3072 sc1
  global_store_dwordx4 v61, v[8:11], s[26:27] offset:3072 sc1
  s_waitcnt vmcnt(0)
  s_mov_b64 exec, 1
  global_store_dword v14, v15, s[24:25] sc1
  s_mov_b64 exec, -1
L_nojan:
  s_lshl_b32 s36, s31, 17
  s_lshl_b32 s37, s32, 15
  s_add_u32 s36, s36, s37
  s_lshl_b32 s37, s30, 14
  s_add_u32 s36, s36, s37
  v_add_u32 v16, s36, v1
  global_load_dwordx4 v[128:131], v16, s[12:13] offset:0
  global_load_dwordx4 v[132:135], v16, s[12:13] offset:1024
  global_load_dwordx4 v[136:139], v16, s[12:13] offset:2048
  global_load_dwordx4 v[140:143], v16, s[12:13] offset:3072
  v_add_u32 v16, 0x1000, v16
  global_load_dwordx4 v[144:147], v16, s[12:13] offset:0
  global_load_dwordx4 v[148:151], v16, s[12:13] offset:1024
  global_load_dwordx4 v[152:155], v16, s[12:13] offset:2048
  global_load_dwordx4 v[156:159], v16, s[12:13] offset:3072
  v_add_u32 v16, 0x1000, v16
  global_load_dwordx4 v[160:163], v16, s[12:13] offset:0
  global_load_dwordx4 v[164:167], v16, s[12:13] offset:1024
  global_load_dwordx4 v[168:171], v16, s[12:13] offset:2048
  global_load_dwordx4 v[172:175], v16, s[12:13] offset:3072
  v_add_u32 v16, 0x1000, v16
  global_load_dwordx4 v[176:179], v16, s[12:13] offset:0
  global_load_dwordx4 v[180:183], v16, s[12:13] offset:1024
  global_load_dwordx4 v[184:187], v16, s[12:13] offset:2048
  global_load_dwordx4 v[188:191], v16, s[12:13] offset:3072
  v_add_u32 v16, 0x1000, v16
  v_mov_b32 v56, 131072
L_pw_fp:
  ds_read_b32 v57, v56
  s_waitcnt lgkmcnt(0)
  v_readfirstlane_b32 s51, v57
  s_cmp_ge_i32 s51, 1
  s_cbranch_scc1 L_pg_fp
  s_sub_u32 s34, s34, 1
  s_cbranch_scc1 L_exit
  s_sleep 4
  s_branch L_pw_fp
L_pg_fp:
  s_lshr_b32 s36, s2, 3
  s_mul_i32 s37, s36, 57344
  s_lshl_b32 s38, s28, 8
  s_add_u32 s37, s37, s38
  s_movk_i32 s39, 3584
  v_mul_lo_u32 v16, v2, s39
  v_lshl_add_u32 v16, v3, 4, v16
  v_add_u32 v16, s37, v16
  v_add_u32 v17, 14336, v16
  v_add_u32 v18, 28672, v16
  v_add_u32 v19, 43008, v16
  s_lshl_b32 s37, s28, 17
  s_lshl_b32 s38, s36, 12
  s_add_u32 s37, s37, s38
  v_add_u32 v20, s37, v1
  v_add_u32 v21, 1048576, v20
  global_load_dwordx4 v[128:131], v16, s[16:17] offset:0
  global_load_dwordx4 v[132:135], v16, s[18:19] offset:0
  global_load_dwordx4 v[136:139], v17, s[16:17] offset:0
  global_load_dwordx4 v[140:143], v17, s[18:19] offset:0
  global_load_dwordx4 v[144:147], v18, s[16:17] offset:0
  global_load_dwordx4 v[148:151], v18, s[18:19] offset:0
  global_load_dwordx4 v[152:155], v19, s[16:17] offset:0
  global_load_dwordx4 v[156:159], v19, s[18:19] offset:0
  global_load_dwordx4 v[160:163], v20, s[20:21] offset:0
  global_load_dwordx4 v[164:167], v20, s[20:21] offset:1024
  global_load_dwordx4 v[168:171], v20, s[20:21] offset:2048
  global_load_dwordx4 v[172:175], v20, s[20:21] offset:3072
  s_cmp_ge_u32 s28, 6
  s_cbranch_scc1 L_fpfd
  global_load_dwordx4 v[176:179], v16, s[16:17] offset:2048
  global_load_dwordx4 v[180:183], v16, s[18:19] offset:2048
  global_load_dwordx4 v[184:187], v17, s[16:17] offset:2048
  global_load_dwordx4 v[188:191], v17, s[18:19] offset:2048
  global_load_dwordx4 v[192:195], v18, s[16:17] offset:2048
  global_load_dwordx4 v[196:199], v18, s[18:19] offset:2048
  global_load_dwordx4 v[200:203], v19, s[16:17] offset:2048
  global_load_dwordx4 v[204:207], v19, s[18:19] offset:2048
  global_load_dwordx4 v[208:211], v21, s[20:21] offset:0
  global_load_dwordx4 v[212:215], v21, s[20:21] offset:1024
  global_load_dwordx4 v[216:219], v21, s[20:21] offset:2048
  global_load_dwordx4 v[220:223], v21, s[20:21] offset:3072
L_fpfd:
  s_waitcnt vmcnt(0)
  s_cmp_ge_u32 s2, 14
  s_cbranch_scc1 L_noffn
  global_load_dwordx4 v[16:19], v1, s[4:5] offset:0
  global_load_dwordx4 v[20:23], v1, s[4:5] offset:1024
  global_load_dwordx4 v[24:27], v1, s[4:5] offset:2048
  global_load_dwordx4 v[28:31], v1, s[4:5] offset:3072
  s_mov_b32 s36, s16
  s_mov_b32 s37, s17
  s_mov_b32 s38, 1835008
  s_mov_b32 s39, 0x20000
  s_mov_b32 s40, s18
  s_mov_b32 s41, s19
  s_mov_b32 s42, 1835008
  s_mov_b32 s43, 0x20000
  s_mov_b32 s44, s20
  s_mov_b32 s45, s21
  s_mov_b32 s46, 1835008
  s_mov_b32 s47, 0x20000
  s_movk_i32 s48, 3584
  v_mul_lo_u32 v61, v2, s48
  v_lshl_add_u32 v61, v3, 4, v61
  s_lshl_b32 s48, s2, 8
  v_and_b32 v8, 1, v3
  v_cmp_eq_u32 vcc, 1, v8
  v_mov_b32 v9, 0xffff
  v_mov_b32 v10, 0xffff0000
  v_bfe_u32 v8, v3, 1, 2
  v_cndmask_b32 v9, v9, v10, vcc
  v_cmp_eq_u32 vcc, 0, v8
  s_nop 1
  v_cndmask_b32 v4, 0, v9, vcc
  v_cmp_eq_u32 vcc, 1, v8
  s_nop 1
  v_cndmask_b32 v5, 0, v9, vcc
  v_cmp_eq_u32 vcc, 2, v8
  s_nop 1
  v_cndmask_b32 v6, 0, v9, vcc
  v_cmp_eq_u32 vcc, 3, v8
  s_nop 1
  v_cndmask_b32 v7, 0, v9, vcc
  s_waitcnt vmcnt(0)
  v_lshlrev_b32 v64, 16, v16
  v_and_b32 v65, 0xffff0000, v16
  v_lshlrev_b32 v66, 16, v17
  v_and_b32 v67, 0xffff0000, v17
  v_lshlrev_b32 v68, 16, v18
  v_and_b32 v69, 0xffff0000, v18
  v_lshlrev_b32 v70, 16, v19
  v_and_b32 v71, 0xffff0000, v19
  v_lshlrev_b32 v72, 16, v20
  v_and_b32 v73, 0xffff0000, v20
  v_lshlrev_b32 v74, 16, v21
  v_and_b32 v75, 0xffff0000, v21
  v_lshlrev_b32 v76, 16, v22
  v_and_b32 v77, 0xffff0000, v22
  v_lshlrev_b32 v78, 16, v23
  v_and_b32 v79, 0xffff0000, v23
  v_lshlrev_b32 v80, 16, v24
  v_and_b32 v81, 0xffff0000, v24
  v_lshlrev_b32 v82, 16, v25
  v_and_b32 v83, 0xffff0000, v25
  v_lshlrev_b32 v84, 16, v26
  v_and_b32 v85, 0xffff0000, v26
  v_lshlrev_b32 v86, 16, v27
  v_and_b32 v87, 0xffff0000, v27
  v_lshlrev_b32 v88, 16, v28
  v_and_b32 v89, 0xffff0000, v28
  v_lshlrev_b32 v90, 16, v29
  v_and_b32 v91, 0xffff0000, v29
  v_lshlrev_b32 v92, 16, v30
  v_and_b32 v93, 0xffff0000, v30
  v_lshlrev_b32 v94, 16, v31
  v_and_b32 v95, 0xffff0000, v31
  v_add_f32 v96, v64, v65
  v_add_f32 v97, v66, v67
  v_add_f32 v98, v68, v69
  v_add_f32 v99, v70, v71
  v_add_f32 v96, v96, v97
  v_add_f32 v98, v98, v99
  v_add_f32 v96, v96, v98
  v_add_f32 v100, v72, v73
  v_add_f32 v101, v74, v75
  v_add_f32 v102, v76, v77
  v_add_f32 v103, v78, v79
  v_add_f32 v100, v100, v101
  v_add_f32 v102, v102, v103
  v_add_f32 v100, v100, v102
  v_add_f32 v104, v80, v81
  v_add_f32 v105, v82, v83
  v_add_f32 v106, v84, v85
  v_add_f32 v107, v86, v87
  v_add_f32 v104, v104, v105
  v_add_f32 v106, v106, v107
  v_add_f32 v104, v104, v106
  v_add_f32 v108, v88, v89
  v_add_f32 v109, v90, v91
  v_add_f32 v110, v92, v93
  v_add_f32 v111, v94, v95
  v_add_f32 v108, v108, v109
  v_add_f32 v110, v110, v111
  v_add_f32 v108, v108, v110
  v_add_f32_dpp v96, v96, v96 row_ror:8 row_mask:0xf bank_mask:0xf
  v_add_f32_dpp v100, v100, v100 row_ror:8 row_mask:0xf bank_mask:0xf
  v_add_f32_dpp v104, v104, v104 row_ror:8 row_mask:0xf bank_mask:0xf
  v_add_f32_dpp v108, v108, v108 row_ror:8 row_mask:0xf bank_mask:0xf
  v_add_f32_dpp v96, v96, v96 row_ror:4 row_mask:0xf bank_mask:0xf
  v_add_f32_dpp v100, v100, v100 row_ror:4 row_mask:0xf bank_mask:0xf
  v_add_f32_dpp v104, v104, v104 row_ror:4 row_mask:0xf bank_mask:0xf
  v_add_f32_dpp v108, v108, v108 row_ror:4 row_mask:0xf bank_mask:0xf
  v_add_f32_dpp v96, v96, v96 row_ror:2 row_mask:0xf bank_mask:0xf
  v_add_f32_dpp v100, v100, v100 row_ror:2 row_mask:0xf bank_mask:0xf
  v_add_f32_dpp v104, v104, v104 row_ror:2 row_mask:0xf bank_mask:0xf
  v_add_f32_dpp v108, v108, v108 row_ror:2 row_mask:0xf bank_mask:0xf
  v_add_f32_dpp v96, v96, v96 row_ror:1 row_mask:0xf bank_mask:0xf
  v_add_f32_dpp v100, v100, v100 row_ror:1 row_mask:0xf bank_mask:0xf
  v_add_f32_dpp v104, v104, v104 row_ror:1 row_mask:0xf bank_mask:0xf
  v_add_f32_dpp v108, v108, v108 row_ror:1 row_mask:0xf bank_mask:0xf
  v_mov_b32 v97, v96
  v_mov_b32 v101, v100
  v_mov_b32 v105, v104
  v_mov_b32 v109, v108
  s_nop 1
  v_permlane16_swap_b32 v96, v97
  v_permlane16_swap_b32 v100, v101
  v_permlane16_swap_b32 v104, v105
  v_permlane16_swap_b32 v108, v109
  s_nop 1
  v_add_f32 v96, v96, v97
  v_add_f32 v100, v100, v101
  v_add_f32 v104, v104, v105
  v_add_f32 v108, v108, v109
  v_mov_b32 v97, v96
  v_mov_b32 v101, v100
  v_mov_b32 v105, v104
  v_mov_b32 v109, v108
  s_nop 1
  v_permlane32_swap_b32 v96, v97
  v_permlane32_swap_b32 v100, v101
  v_permlane32_swap_b32 v104, v105
  v_permlane32_swap_b32 v108, v109
  s_nop 1
  v_add_f32 v96, v96, v97
  v_add_f32 v100, v100, v101
  v_add_f32 v104, v104, v105
  v_add_f32 v108, v108, v109
  v_mul_f32 v96, 0x3b000000, v96
  v_sub_f32 v98, v64, v96
  v_mul_f32 v97, v98, v98
  v_sub_f32 v98, v65, v96
  v_fmac_f32 v97, v98, v98
  v_sub_f32 v98, v66, v96
  v_fmac_f32 v97, v98, v98
  v_sub_f32 v98, v67, v96
  v_fmac_f32 v97, v98, v98
  v_sub_f32 v98, v68, v96
  v_fmac_f32 v97, v98, v98
  v_sub_f32 v98, v69, v96
  v_fmac_f32 v97, v98, v98
  v_sub_f32 v98, v70, v96
  v_fmac_f32 v97, v98, v98
  v_sub_f32 v98, v71, v96
  v_fmac_f32 v97, v98, v98
  v_mul_f32 v100, 0x3b000000, v100
  v_sub_f32 v102, v72, v100
  v_mul_f32 v101, v102, v102
  v_sub_f32 v102, v73, v100
  v_fmac_f32 v101, v102, v102
  v_sub_f32 v102, v74, v100
  v_fmac_f32 v101, v102, v102
  v_sub_f32 v102, v75, v100
  v_fmac_f32 v101, v102, v102
  v_sub_f32 v102, v76, v100
  v_fmac_f32 v101, v102, v102
  v_sub_f32 v102, v77, v100
  v_fmac_f32 v101, v102, v102
  v_sub_f32 v102, v78, v100
  v_fmac_f32 v101, v102, v102
  v_sub_f32 v102, v79, v100
  v_fmac_f32 v101, v102, v102
  v_mul_f32 v104, 0x3b000000, v104
  v_sub_f32 v106, v80, v104
  v_mul_f32 v105, v106, v106
  v_sub_f32 v106, v81, v104
  v_fmac_f32 v105, v106, v106
  v_sub_f32 v106, v82, v104
  v_fmac_f32 v105, v106, v106
  v_sub_f32 v106, v83, v104
  v_fmac_f32 v105, v106, v106
  v_sub_f32 v106, v84, v104
  v_fmac_f32 v105, v106, v106
  v_sub_f32 v106, v85, v104
  v_fmac_f32 v105, v106, v106
  v_sub_f32 v106, v86, v104
  v_fmac_f32 v105, v106, v106
  v_sub_f32 v106, v87, v104
  v_fmac_f32 v105, v106, v106
  v_mul_f32 v108, 0x3b000000, v108
  v_sub_f32 v110, v88, v108
  v_mul_f32 v109, v110, v110
  v_sub_f32 v110, v89, v108
  v_fmac_f32 v109, v110, v110
  v_sub_f32 v110, v90, v108
  v_fmac_f32 v109, v110, v110
  v_sub_f32 v110, v91, v108
  v_fmac_f32 v109, v110, v110
  v_sub_f32 v110, v92, v108
  v_fmac_f32 v109, v110, v110
  v_sub_f32 v110, v93, v108
  v_fmac_f32 v109, v110, v110
  v_sub_f32 v110, v94, v108
  v_fmac_f32 v109, v110, v110
  v_sub_f32 v110, v95, v108
  v_fmac_f32 v109, v110, v110
  v_add_f32_dpp v97, v97, v97 row_ror:8 row_mask:0xf bank_mask:0xf
  v_add_f32_dpp v101, v101, v101 row_ror:8 row_mask:0xf bank_mask:0xf
  v_add_f32_dpp v105, v105, v105 row_ror:8 row_mask:0xf bank_mask:0xf
  v_add_f32_dpp v109, v109, v109 row_ror:8 row_mask:0xf bank_mask:0xf
  v_add_f32_dpp v97, v97, v97 row_ror:4 row_mask:0xf bank_mask:0xf
  v_add_f32_dpp v101, v101, v101 row_ror:4 row_mask:0xf bank_mask:0xf
  v_add_f32_dpp v105, v105, v105 row_ror:4 row_mask:0xf bank_mask:0xf
  v_add_f32_dpp v109, v109, v109 row_ror:4 row_mask:0xf bank_mask:0xf
  v_add_f32_dpp v97, v97, v97 row_ror:2 row_mask:0xf bank_mask:0xf
  v_add_f32_dpp v101, v101, v101 row_ror:2 row_mask:0xf bank_mask:0xf
  v_add_f32_dpp v105, v105, v105 row_ror:2 row_mask:0xf bank_mask:0xf
  v_add_f32_dpp v109, v109, v109 row_ror:2 row_mask:0xf bank_mask:0xf
  v_add_f32_dpp v97, v97, v97 row_ror:1 row_mask:0xf bank_mask:0xf
  v_add_f32_dpp v101, v101, v101 row_ror:1 row_mask:0xf bank_mask:0xf
  v_add_f32_dpp v105, v105, v105 row_ror:1 row_mask:0xf bank_mask:0xf
  v_add_f32_dpp v109, v109, v109 row_ror:1 row_mask:0xf bank_mask:0xf
  v_mov_b32 v98, v97
  v_mov_b32 v102, v101
  v_mov_b32 v106, v105
  v_mov_b32 v110, v109
  s_nop 1
  v_permlane16_swap_b32 v97, v98
  v_permlane16_swap_b32 v101, v102
  v_permlane16_swap_b32 v105, v106
  v_permlane16_swap_b32 v109, v110
  s_nop 1
  v_add_f32 v97, v97, v98
  v_add_f32 v101, v101, v102
  v_add_f32 v105, v105, v106
  v_add_f32 v109, v109, v110
  v_mov_b32 v98, v97
  v_mov_b32 v102, v101
  v_mov_b32 v106, v105
  v_mov_b32 v110, v109
  s_nop 1
  v_permlane32_swap_b32 v97, v98
  v_permlane32_swap_b32 v101, v102
  v_permlane32_swap_b32 v105, v106
  v_permlane32_swap_b32 v109, v110
  s_nop 1
  v_add_f32 v97, v97, v98
  v_add_f32 v101, v101, v102
  v_add_f32 v105, v105, v106
  v_add_f32 v109, v109, v110
  v_mul_f32 v97, 0x3b000000, v97
  v_cvt_pk_bf16_f32 v97, v97, v97
  v_and_b32 v97, 0xffff0000, v97
  v_add_f32 v97, 0x3727c5ac, v97
  v_cvt_pk_bf16_f32 v97, v97, v97
  v_and_b32 v97, 0xffff0000, v97
  v_sqrt_f32 v97, v97
  v_cvt_pk_bf16_f32 v96, v96, v96
  v_and_b32 v96, 0xffff0000, v96
  v_cvt_pk_bf16_f32 v97, v97, v97
  v_and_b32 v97, 0xffff0000, v97
  v_rcp_f32 v98, v97
  v_sub_f32 v64, v64, v96
  v_sub_f32 v65, v65, v96
  v_sub_f32 v66, v66, v96
  v_sub_f32 v67, v67, v96
  v_sub_f32 v68, v68, v96
  v_sub_f32 v69, v69, v96
  v_sub_f32 v70, v70, v96
  v_sub_f32 v71, v71, v96
  v_cvt_pk_bf16_f32 v64, v64, v64
  v_and_b32 v64, 0xffff0000, v64
  v_cvt_pk_bf16_f32 v65, v65, v65
  v_and_b32 v65, 0xffff0000, v65
  v_cvt_pk_bf16_f32 v66, v66, v66
  v_and_b32 v66, 0xffff0000, v66
  v_cvt_pk_bf16_f32 v67, v67, v67
  v_and_b32 v67, 0xffff0000, v67
  v_cvt_pk_bf16_f32 v68, v68, v68
  v_and_b32 v68, 0xffff0000, v68
  v_cvt_pk_bf16_f32 v69, v69, v69
  v_and_b32 v69, 0xffff0000, v69
  v_cvt_pk_bf16_f32 v70, v70, v70
  v_and_b32 v70, 0xffff0000, v70
  v_cvt_pk_bf16_f32 v71, v71, v71
  v_and_b32 v71, 0xffff0000, v71
  v_mul_f32 v99, v64, v98
  v_fma_f32 v64, -v99, v97, v64
  v_fma_f32 v64, v64, v98, v99
  v_mul_f32 v99, v65, v98
  v_fma_f32 v65, -v99, v97, v65
  v_fma_f32 v65, v65, v98, v99
  v_mul_f32 v99, v66, v98
  v_fma_f32 v66, -v99, v97, v66
  v_fma_f32 v66, v66, v98, v99
  v_mul_f32 v99, v67, v98
  v_fma_f32 v67, -v99, v97, v67
  v_fma_f32 v67, v67, v98, v99
  v_mul_f32 v99, v68, v98
  v_fma_f32 v68, -v99, v97, v68
  v_fma_f32 v68, v68, v98, v99
  v_mul_f32 v99, v69, v98
  v_fma_f32 v69, -v99, v97, v69
  v_fma_f32 v69, v69, v98, v99
  v_mul_f32 v99, v70, v98
  v_fma_f32 v70, -v99, v97, v70
  v_fma_f32 v70, v70, v98, v99
  v_mul_f32 v99, v71, v98
  v_fma_f32 v71, -v99, v97, v71
  v_fma_f32 v71, v71, v98, v99
  v_mul_f32 v101, 0x3b000000, v101
  v_cvt_pk_bf16_f32 v101, v101, v101
  v_and_b32 v101, 0xffff0000, v101
  v_add_f32 v101, 0x3727c5ac, v101
  v_cvt_pk_bf16_f32 v101, v101, v101
  v_and_b32 v101, 0xffff0000, v101
  v_sqrt_f32 v101, v101
  v_cvt_pk_bf16_f32 v100, v100, v100
  v_and_b32 v100, 0xffff0000, v100
  v_cvt_pk_bf16_f32 v101, v101, v101
  v_and_b32 v101, 0xffff0000, v101
  v_rcp_f32 v102, v101
  v_sub_f32 v72, v72, v100
  v_sub_f32 v73, v73, v100
  v_sub_f32 v74, v74, v100
  v_sub_f32 v75, v75, v100
  v_sub_f32 v76, v76, v100
  v_sub_f32 v77, v77, v100
  v_sub_f32 v78, v78, v100
  v_sub_f32 v79, v79, v100
  v_cvt_pk_bf16_f32 v72, v72, v72
  v_and_b32 v72, 0xffff0000, v72
  v_cvt_pk_bf16_f32 v73, v73, v73
  v_and_b32 v73, 0xffff0000, v73
  v_cvt_pk_bf16_f32 v74, v74, v74
  v_and_b32 v74, 0xffff0000, v74
  v_cvt_pk_bf16_f32 v75, v75, v75
  v_and_b32 v75, 0xffff0000, v75
  v_cvt_pk_bf16_f32 v76, v76, v76
  v_and_b32 v76, 0xffff0000, v76
  v_cvt_pk_bf16_f32 v77, v77, v77
  v_and_b32 v77, 0xffff0000, v77
  v_cvt_pk_bf16_f32 v78, v78, v78
  v_and_b32 v78, 0xffff0000, v78
  v_cvt_pk_bf16_f32 v79, v79, v79
  v_and_b32 v79, 0xffff0000, v79
  v_mul_f32 v103, v72, v102
  v_fma_f32 v72, -v103, v101, v72
  v_fma_f32 v72, v72, v102, v103
  v_mul_f32 v103, v73, v102
  v_fma_f32 v73, -v103, v101, v73
  v_fma_f32 v73, v73, v102, v103
  v_mul_f32 v103, v74, v102
  v_fma_f32 v74, -v103, v101, v74
  v_fma_f32 v74, v74, v102, v103
  v_mul_f32 v103, v75, v102
  v_fma_f32 v75, -v103, v101, v75
  v_fma_f32 v75, v75, v102, v103
  v_mul_f32 v103, v76, v102
  v_fma_f32 v76, -v103, v101, v76
  v_fma_f32 v76, v76, v102, v103
  v_mul_f32 v103, v77, v102
  v_fma_f32 v77, -v103, v101, v77
  v_fma_f32 v77, v77, v102, v103
  v_mul_f32 v103, v78, v102
  v_fma_f32 v78, -v103, v101, v78
  v_fma_f32 v78, v78, v102, v103
  v_mul_f32 v103, v79, v102
  v_fma_f32 v79, -v103, v101, v79
  v_fma_f32 v79, v79, v102, v103
  v_mul_f32 v105, 0x3b000000, v105
  v_cvt_pk_bf16_f32 v105, v105, v105
  v_and_b32 v105, 0xffff0000, v105
  v_add_f32 v105, 0x3727c5ac, v105
  v_cvt_pk_bf16_f32 v105, v105, v105
  v_and_b32 v105, 0xffff0000, v105
  v_sqrt_f32 v105, v105
  v_cvt_pk_bf16_f32 v104, v104, v104
  v_and_b32 v104, 0xffff0000, v104
  v_cvt_pk_bf16_f32 v105, v105, v105
  v_and_b32 v105, 0xffff0000, v105
  v_rcp_f32 v106, v105
  v_sub_f32 v80, v80, v104
  v_sub_f32 v81, v81, v104
  v_sub_f32 v82, v82, v104
  v_sub_f32 v83, v83, v104
  v_sub_f32 v84, v84, v104
  v_sub_f32 v85, v85, v104
  v_sub_f32 v86, v86, v104
  v_sub_f32 v87, v87, v104
  v_cvt_pk_bf16_f32 v80, v80, v80
  v_and_b32 v80, 0xffff0000, v80
  v_cvt_pk_bf16_f32 v81, v81, v81
  v_and_b32 v81, 0xffff0000, v81
  v_cvt_pk_bf16_f32 v82, v82, v82
  v_and_b32 v82, 0xffff0000, v82
  v_cvt_pk_bf16_f32 v83, v83, v83
  v_and_b32 v83, 0xffff0000, v83
  v_cvt_pk_bf16_f32 v84, v84, v84
  v_and_b32 v84, 0xffff0000, v84
  v_cvt_pk_bf16_f32 v85, v85, v85
  v_and_b32 v85, 0xffff0000, v85
  v_cvt_pk_bf16_f32 v86, v86, v86
  v_and_b32 v86, 0xffff0000, v86
  v_cvt_pk_bf16_f32 v87, v87, v87
  v_and_b32 v87, 0xffff0000, v87
  v_mul_f32 v107, v80, v106
  v_fma_f32 v80, -v107, v105, v80
  v_fma_f32 v80, v80, v106, v107
  v_mul_f32 v107, v81, v106
  v_fma_f32 v81, -v107, v105, v81
  v_fma_f32 v81, v81, v106, v107
  v_mul_f32 v107, v82, v106
  v_fma_f32 v82, -v107, v105, v82
  v_fma_f32 v82, v82, v106, v107
  v_mul_f32 v107, v83, v106
  v_fma_f32 v83, -v107, v105, v83
  v_fma_f32 v83, v83, v106, v107
  v_mul_f32 v107, v84, v106
  v_fma_f32 v84, -v107, v105, v84
  v_fma_f32 v84, v84, v106, v107
  v_mul_f32 v107, v85, v106
  v_fma_f32 v85, -v107, v105, v85
  v_fma_f32 v85, v85, v106, v107
  v_mul_f32 v107, v86, v106
  v_fma_f32 v86, -v107, v105, v86
  v_fma_f32 v86, v86, v106, v107
  v_mul_f32 v107, v87, v106
  v_fma_f32 v87, -v107, v105, v87
  v_fma_f32 v87, v87, v106, v107
  v_mul_f32 v109, 0x3b000000, v109
  v_cvt_pk_bf16_f32 v109, v109, v109
  v_and_b32 v109, 0xffff0000, v109
  v_add_f32 v109, 0x3727c5ac, v109
  v_cvt_pk_bf16_f32 v109, v109, v109
  v_and_b32 v109, 0xffff0000, v109
  v_sqrt_f32 v109, v109
  v_cvt_pk_bf16_f32 v108, v108, v108
  v_and_b32 v108, 0xffff0000, v108
  v_cvt_pk_bf16_f32 v109, v109, v109
  v_and_b32 v109, 0xffff0000, v109
  v_rcp_f32 v110, v109
  v_sub_f32 v88, v88, v108
  v_sub_f32 v89, v89, v108
  v_sub_f32 v90, v90, v108
  v_sub_f32 v91, v91, v108
  v_sub_f32 v92, v92, v108
  v_sub_f32 v93, v93, v108
  v_sub_f32 v94, v94, v108
  v_sub_f32 v95, v95, v108
  v_cvt_pk_bf16_f32 v88, v88, v88
  v_and_b32 v88, 0xffff0000, v88
  v_cvt_pk_bf16_f32 v89, v89, v89
  v_and_b32 v89, 0xffff0000, v89
  v_cvt_pk_bf16_f32 v90, v90, v90
  v_and_b32 v90, 0xffff0000, v90
  v_cvt_pk_bf16_f32 v91, v91, v91
  v_and_b32 v91, 0xffff0000, v91
  v_cvt_pk_bf16_f32 v92, v92, v92
  v_and_b32 v92, 0xffff0000, v92
  v_cvt_pk_bf16_f32 v93, v93, v93
  v_and_b32 v93, 0xffff0000, v93
  v_cvt_pk_bf16_f32 v94, v94, v94
  v_and_b32 v94, 0xffff0000, v94
  v_cvt_pk_bf16_f32 v95, v95, v95
  v_and_b32 v95, 0xffff0000, v95
  v_mul_f32 v111, v88, v110
  v_fma_f32 v88, -v111, v109, v88
  v_fma_f32 v88, v88, v110, v111
  v_mul_f32 v111, v89, v110
  v_fma_f32 v89, -v111, v109, v89
  v_fma_f32 v89, v89, v110, v111
  v_mul_f32 v111, v90, v110
  v_fma_f32 v90, -v111, v109, v90
  v_fma_f32 v90, v90, v110, v111
  v_mul_f32 v111, v91, v110
  v_fma_f32 v91, -v111, v109, v91
  v_fma_f32 v91, v91, v110, v111
  v_mul_f32 v111, v92, v110
  v_fma_f32 v92, -v111, v109, v92
  v_fma_f32 v92, v92, v110, v111
  v_mul_f32 v111, v93, v110
  v_fma_f32 v93, -v111, v109, v93
  v_fma_f32 v93, v93, v110, v111
  v_mul_f32 v111, v94, v110
  v_fma_f32 v94, -v111, v109, v94
  v_fma_f32 v94, v94, v110, v111
  v_mul_f32 v111, v95, v110
  v_fma_f32 v95, -v111, v109, v95
  v_fma_f32 v95, v95, v110, v111
  v_lshlrev_b32 v62, 3, v0
  v_add_u32 v62, 155648, v62
  v_cvt_pk_bf16_f32 v112, v64, v64
  v_cvt_pk_bf16_f32 v113, v68, v68
  v_cvt_pk_bf16_f32 v114, v65, v65
  v_cvt_pk_bf16_f32 v115, v69, v69
  v_cvt_pk_bf16_f32 v116, v66, v66
  v_cvt_pk_bf16_f32 v117, v70, v70
  v_cvt_pk_bf16_f32 v118, v67, v67
  v_cvt_pk_bf16_f32 v119, v71, v71
  ds_write_b64 v62, v[112:113] offset:0
  ds_write_b64 v62, v[114:115] offset:512
  ds_write_b64 v62, v[116:117] offset:1024
  ds_write_b64 v62, v[118:119] offset:1536
  v_cvt_pk_bf16_f32 v112, v72, v72
  v_cvt_pk_bf16_f32 v113, v76, v76
  v_cvt_pk_bf16_f32 v114, v73, v73
  v_cvt_pk_bf16_f32 v115, v77, v77
  v_cvt_pk_bf16_f32 v116, v74, v74
  v_cvt_pk_bf16_f32 v117, v78, v78
  v_cvt_pk_bf16_f32 v118, v75, v75
  v_cvt_pk_bf16_f32 v119, v79, v79
  ds_write_b64 v62, v[112:113] offset:2048
  ds_write_b64 v62, v[114:115] offset:2560
  ds_write_b64 v62, v[116:117] offset:3072
  ds_write_b64 v62, v[118:119] offset:3584
  v_cvt_pk_bf16_f32 v112, v80, v80
  v_cvt_pk_bf16_f32 v113, v84, v84
  v_cvt_pk_bf16_f32 v114, v81, v81
  v_cvt_pk_bf16_f32 v115, v85, v85
  v_cvt_pk_bf16_f32 v116, v82, v82
  v_cvt_pk_bf16_f32 v117, v86, v86
  v_cvt_pk_bf16_f32 v118, v83, v83
  v_cvt_pk_bf16_f32 v119, v87, v87
  ds_write_b64 v62, v[112:113] offset:4096
  ds_write_b64 v62, v[114:115] offset:4608
  ds_write_b64 v62, v[116:117] offset:5120
  ds_write_b64 v62, v[118:119] offset:5632
  v_cvt_pk_bf16_f32 v112, v88, v88
  v_cvt_pk_bf16_f32 v113, v92, v92
  v_cvt_pk_bf16_f32 v114, v89, v89
  v_cvt_pk_bf16_f32 v115, v93, v93
  v_cvt_pk_bf16_f32 v116, v90, v90
  v_cvt_pk_bf16_f32 v117, v94, v94
  v_cvt_pk_bf16_f32 v118, v91, v91
  v_cvt_pk_bf16_f32 v119, v95, v95
  ds_write_b64 v62, v[112:113] offset:6144
  ds_write_b64 v62, v[114:115] offset:6656
  ds_write_b64 v62, v[116:117] offset:7168
  ds_write_b64 v62, v[118:119] offset:7680
  v_lshrrev_b32 v62, 3, v3
  v_lshlrev_b32 v62, 11, v62
  v_lshl_add_u32 v62, v2, 9, v62
  v_add_u32 v62, 155648, v62
  v_mov_b32 v32, 0
  v_mov_b32 v33, 0
  v_mov_b32 v34, 0
  v_mov_b32 v35, 0
  v_mov_b32 v36, 0
  v_mov_b32 v37, 0
  v_mov_b32 v38, 0
  v_mov_b32 v39, 0
  v_mov_b32 v40, 0
  v_mov_b32 v41, 0
  v_mov_b32 v42, 0
  v_mov_b32 v43, 0
  v_mov_b32 v44, 0
  v_mov_b32 v45, 0
  v_mov_b32 v46, 0
  v_mov_b32 v47, 0
  v_mov_b32 v56, 131072
L_pw_p1:
  ds_read_b32 v57, v56
  s_waitcnt lgkmcnt(0)
  v_readfirstlane_b32 s51, v57
  s_cmp_ge_i32 s51, s52
  s_cbranch_scc1 L_pg_p1
  s_sub_u32 s34, s34, 1
  s_cbranch_scc1 L_exit
  s_sleep 4
  s_branch L_pw_p1
L_pg_p1:
  s_add_u32 s52, s52, 3
  buffer_load_dwordx4 v[128:131], v61, s[36:39], s48 offen nt
  buffer_load_dwordx4 v[132:135], v61, s[40:43], s48 offen nt
  s_add_u32 s48, s48, 14336
  buffer_load_dwordx4 v[136:139], v61, s[36:39], s48 offen nt
  buffer_load_dwordx4 v[140:143], v61, s[40:43], s48 offen nt
  s_add_u32 s48, s48, 14336
  buffer_load_dwordx4 v[144:147], v61, s[36:39], s48 offen nt
  buffer_load_dwordx4 v[148:151], v61, s[40:43], s48 offen nt
  s_add_u32 s48, s48, 14336
  buffer_load_dwordx4 v[152:155], v61, s[36:39], s48 offen nt
  buffer_load_dwordx4 v[156:159], v61, s[40:43], s48 offen nt
  s_add_u32 s48, s48, 14336
  buffer_load_dwordx4 v[160:163], v61, s[36:39], s48 offen nt
  buffer_load_dwordx4 v[164:167], v61, s[40:43], s48 offen nt
  s_add_u32 s48, s48, 14336
  buffer_load_dwordx4 v[168:171], v61, s[36:39], s48 offen nt
  buffer_load_dwordx4 v[172:175], v61, s[40:43], s48 offen nt
  s_add_u32 s48, s48, 14336
  buffer_load_dwordx4 v[176:179], v61, s[36:39], s48 offen nt
  buffer_load_dwordx4 v[180:183], v61, s[40:43], s48 offen nt
  s_add_u32 s48, s48, 14336
  buffer_load_dwordx4 v[184:187], v61, s[36:39], s48 offen nt
  buffer_load_dwordx4 v[188:191], v61, s[40:43], s48 offen nt
  s_add_u32 s48, s48, 14336
  v_mov_b32 v56, 131072
L_pw_p2:
  ds_read_b32 v57, v56
  s_waitcnt lgkmcnt(0)
  v_readfirstlane_b32 s51, v57
  s_cmp_ge_i32 s51, s52
  s_cbranch_scc1 L_pg_p2
  s_sub_u32 s34, s34, 1
  s_cbranch_scc1 L_exit
  s_sleep 4
  s_branch L_pw_p2
L_pg_p2:
  s_add_u32 s52, s52, 3
  buffer_load_dwordx4 v[192:195], v61, s[36:39], s48 offen nt
  buffer_load_dwordx4 v[196:199], v61, s[40:43], s48 offen nt
  s_add_u32 s48, s48, 14336
  buffer_load_dwordx4 v[200:203], v61, s[36:39], s48 offen nt
  buffer_load_dwordx4 v[204:207], v61, s[40:43], s48 offen nt
  s_add_u32 s48, s48, 14336
  buffer_load_dwordx4 v[208:211], v61, s[36:39], s48 offen nt
  buffer_load_dwordx4 v[212:215], v61, s[40:43], s48 offen nt
  s_add_u32 s48, s48, 14336
  buffer_load_dwordx4 v[216:219], v61, s[36:39], s48 offen nt
  buffer_load_dwordx4 v[220:223], v61, s[40:43], s48 offen nt
  s_add_u32 s48, s48, 14336
  buffer_load_dwordx4 v[224:227], v61, s[36:39], s48 offen nt
  buffer_load_dwordx4 v[228:231], v61, s[40:43], s48 offen nt
  s_add_u32 s48, s48, 14336
  buffer_load_dwordx4 v[232:235], v61, s[36:39], s48 offen nt
  buffer_load_dwordx4 v[236:239], v61, s[40:43], s48 offen nt
  s_add_u32 s48, s48, 14336
  buffer_load_dwordx4 v[240:243], v61, s[36:39], s48 offen nt
  buffer_load_dwordx4 v[244:247], v61, s[40:43], s48 offen nt
  s_add_u32 s48, s48, 14336
  buffer_load_dwordx4 v[248:251], v61, s[36:39], s48 offen nt
  buffer_load_dwordx4 v[252:255], v61, s[40:43], s48 offen nt
  s_add_u32 s48, s48, 14336
  s_mov_b32 s49, 0
L_ffn1:
  ds_read_b128 v[64:67], v62 offset:0
  ds_read_b128 v[68:71], v62 offset:16
  ds_read_b128 v[72:75], v62 offset:4096
  ds_read_b128 v[76:79], v62 offset:4112
  s_waitcnt vmcnt(16) lgkmcnt(0)
  v_and_b32 v8, v64, v4
  v_and_b32 v9, v64, v5
  v_and_b32 v10, v64, v6
  v_and_b32 v11, v64, v7
  v_and_b32 v12, v72, v4
  v_and_b32 v13, v72, v5
  v_and_b32 v14, v72, v6
  v_and_b32 v15, v72, v7
  s_nop 1
  v_mfma_f32_16x16x32_bf16 v[32:35], v[8:11], v[128:131], v[32:35]
  v_mfma_f32_16x16x32_bf16 v[40:43], v[8:11], v[132:135], v[40:43]
  v_mfma_f32_16x16x32_bf16 v[36:39], v[12:15], v[128:131], v[36:39]
  v_mfma_f32_16x16x32_bf16 v[44:47], v[12:15], v[132:135], v[44:47]
  v_and_b32 v16, v65, v4
  v_and_b32 v17, v65, v5
  v_and_b32 v18, v65, v6
  v_and_b32 v19, v65, v7
  v_and_b32 v20, v73, v4
  v_and_b32 v21, v73, v5
  v_and_b32 v22, v73, v6
  v_and_b32 v23, v73, v7
  s_nop 1
  v_mfma_f32_16x16x32_bf16 v[32:35], v[16:19], v[136:139], v[32:35]
  v_mfma_f32_16x16x32_bf16 v[40:43], v[16:19], v[140:143], v[40:43]
  v_mfma_f32_16x16x32_bf16 v[36:39], v[20:23], v[136:139], v[36:39]
  v_mfma_f32_16x16x32_bf16 v[44:47], v[20:23], v[140:143], v[44:47]
  v_and_b32 v8, v66, v4
  v_and_b32 v9, v66, v5
  v_and_b32 v10, v66, v6
  v_and_b32 v11, v66, v7
  v_and_b32 v12, v74, v4
  v_and_b32 v13, v74, v5
  v_and_b32 v14, v74, v6
  v_and_b32 v15, v74, v7
  s_nop 1
  v_mfma_f32_16x16x32_bf16 v[32:35], v[8:11], v[144:147], v[32:35]
  v_mfma_f32_16x16x32_bf16 v[40:43], v[8:11], v[148:151], v[40:43]
  v_mfma_f32_16x16x32_bf16 v[36:39], v[12:15], v[144:147], v[36:39]
  v_mfma_f32_16x16x32_bf16 v[44:47], v[12:15], v[148:151], v[44:47]
  v_and_b32 v16, v67, v4
  v_and_b32 v17, v67, v5
  v_and_b32 v18, v67, v6
  v_and_b32 v19, v67, v7
  v_and_b32 v20, v75, v4
  v_and_b32 v21, v75, v5
  v_and_b32 v22, v75, v6
  v_and_b32 v23, v75, v7
  s_nop 1
  v_mfma_f32_16x16x32_bf16 v[32:35], v[16:19], v[152:155], v[32:35]
  v_mfma_f32_16x16x32_bf16 v[40:43], v[16:19], v[156:159], v[40:43]
  v_mfma_f32_16x16x32_bf16 v[36:39], v[20:23], v[152:155], v[36:39]
  v_mfma_f32_16x16x32_bf16 v[44:47], v[20:23], v[156:159], v[44:47]
  v_and_b32 v8, v68, v4
  v_and_b32 v9, v68, v5
  v_and_b32 v10, v68, v6
  v_and_b32 v11, v68, v7
  v_and_b32 v12, v76, v4
  v_and_b32 v13, v76, v5
  v_and_b32 v14, v76, v6
  v_and_b32 v15, v76, v7
  s_nop 1
  v_mfma_f32_16x16x32_bf16 v[32:35], v[8:11], v[160:163], v[32:35]
  v_mfma_f32_16x16x32_bf16 v[40:43], v[8:11], v[164:167], v[40:43]
  v_mfma_f32_16x16x32_bf16 v[36:39], v[12:15], v[160:163], v[36:39]
  v_mfma_f32_16x16x32_bf16 v[44:47], v[12:15], v[164:167], v[44:47]
  v_and_b32 v16, v69, v4
  v_and_b32 v17, v69, v5
  v_and_b32 v18, v69, v6
  v_and_b32 v19, v69, v7
  v_and_b32 v20, v77, v4
  v_and_b32 v21, v77, v5
  v_and_b32 v22, v77, v6
  v_and_b32 v23, v77, v7
  s_nop 1
  v_mfma_f32_16x16x32_bf16 v[32:35], v[16:19], v[168:171], v[32:35]
  v_mfma_f32_16x16x32_bf16 v[40:43], v[16:19], v[172:175], v[40:43]
  v_mfma_f32_16x16x32_bf16 v[36:39], v[20:23], v[168:171], v[36:39]
  v_mfma_f32_16x16x32_bf16 v[44:47], v[20:23], v[172:175], v[44:47]
  v_and_b32 v8, v70, v4
  v_and_b32 v9, v70, v5
  v_and_b32 v10, v70, v6
  v_and_b32 v11, v70, v7
  v_and_b32 v12, v78, v4
  v_and_b32 v13, v78, v5
  v_and_b32 v14, v78, v6
  v_and_b32 v15, v78, v7
  s_nop 1
  v_mfma_f32_16x16x32_bf16 v[32:35], v[8:11], v[176:179], v[32:35]
  v_mfma_f32_16x16x32_bf16 v[40:43], v[8:11], v[180:183], v[40:43]
  v_mfma_f32_16x16x32_bf16 v[36:39], v[12:15], v[176:179], v[36:39]
  v_mfma_f32_16x16x32_bf16 v[44:47], v[12:15], v[180:183], v[44:47]
  v_and_b32 v16, v71, v4
  v_and_b32 v17, v71, v5
  v_and_b32 v18, v71, v6
  v_and_b32 v19, v71, v7
  v_and_b32 v20, v79, v4
  v_and_b32 v21, v79, v5
  v_and_b32 v22, v79, v6
  v_and_b32 v23, v79, v7
  s_nop 1
  v_mfma_f32_16x16x32_bf16 v[32:35], v[16:19], v[184:187], v[32:35]
  v_mfma_f32_16x16x32_bf16 v[40:43], v[16:19], v[188:191], v[40:43]
  v_mfma_f32_16x16x32_bf16 v[36:39], v[20:23], v[184:187], v[36:39]
  v_mfma_f32_16x16x32_bf16 v[44:47], v[20:23], v[188:191], v[44:47]
  s_nop 7
  v_mov_b32 v56, 131072
L_pw_p3:
  ds_read_b32 v57, v56
  s_waitcnt lgkmcnt(0)
  v_readfirstlane_b32 s51, v57
  s_cmp_ge_i32 s51, s52
  s_cbranch_scc1 L_pg_p3
  s_sub_u32 s34, s34, 1
  s_cbranch_scc1 L_exit
  s_sleep 4
  s_branch L_pw_p3
L_pg_p3:
  s_add_u32 s52, s52, 3
  buffer_load_dwordx4 v[128:131], v61, s[36:39], s48 offen nt
  buffer_load_dwordx4 v[132:135], v61, s[40:43], s48 offen nt
  s_add_u32 s48, s48, 14336
  buffer_load_dwordx4 v[136:139], v61, s[36:39], s48 offen nt
  buffer_load_dwordx4 v[140:143], v61, s[40:43], s48 offen nt
  s_add_u32 s48, s48, 14336
  buffer_load_dwordx4 v[144:147], v61, s[36:39], s48 offen nt
  buffer_load_dwordx4 v[148:151], v61, s[40:43], s48 offen nt
  s_add_u32 s48, s48, 14336
  buffer_load_dwordx4 v[152:155], v61, s[36:39], s48 offen nt
  buffer_load_dwordx4 v[156:159], v61, s[40:43], s48 offen nt
  s_add_u32 s48, s48, 14336
  buffer_load_dwordx4 v[160:163], v61, s[36:39], s48 offen nt
  buffer_load_dwordx4 v[164:167], v61, s[40:43], s48 offen nt
  s_add_u32 s48, s48, 14336
  buffer_load_dwordx4 v[168:171], v61, s[36:39], s48 offen nt
  buffer_load_dwordx4 v[172:175], v61, s[40:43], s48 offen nt
  s_add_u32 s48, s48, 14336
  buffer_load_dwordx4 v[176:179], v61, s[36:39], s48 offen nt
  buffer_load_dwordx4 v[180:183], v61, s[40:43], s48 offen nt
  s_add_u32 s48, s48, 14336
  buffer_load_dwordx4 v[184:187], v61, s[36:39], s48 offen nt
  buffer_load_dwordx4 v[188:191], v61, s[40:43], s48 offen nt
  s_add_u32 s48, s48, 14336
  ds_read_b128 v[64:67], v62 offset:32
  ds_read_b128 v[68:71], v62 offset:48
  ds_read_b128 v[72:75], v62 offset:4128
  ds_read_b128 v[76:79], v62 offset:4144
  s_waitcnt vmcnt(16) lgkmcnt(0)
  v_and_b32 v8, v64, v4
  v_and_b32 v9, v64, v5
  v_and_b32 v10, v64, v6
  v_and_b32 v11, v64, v7
  v_and_b32 v12, v72, v4
  v_and_b32 v13, v72, v5
  v_and_b32 v14, v72, v6
  v_and_b32 v15, v72, v7
  s_nop 1
  v_mfma_f32_16x16x32_bf16 v[32:35], v[8:11], v[192:195], v[32:35]
  v_mfma_f32_16x16x32_bf16 v[40:43], v[8:11], v[196:199], v[40:43]
  v_mfma_f32_16x16x32_bf16 v[36:39], v[12:15], v[192:195], v[36:39]
  v_mfma_f32_16x16x32_bf16 v[44:47], v[12:15], v[196:199], v[44:47]
  v_and_b32 v16, v65, v4
  v_and_b32 v17, v65, v5
  v_and_b32 v18, v65, v6
  v_and_b32 v19, v65, v7
  v_and_b32 v20, v73, v4
  v_and_b32 v21, v73, v5
  v_and_b32 v22, v73, v6
  v_and_b32 v23, v73, v7
  s_nop 1
  v_mfma_f32_16x16x32_bf16 v[32:35], v[16:19], v[200:203], v[32:35]
  v_mfma_f32_16x16x32_bf16 v[40:43], v[16:19], v[204:207], v[40:43]
  v_mfma_f32_16x16x32_bf16 v[36:39], v[20:23], v[200:203], v[36:39]
  v_mfma_f32_16x16x32_bf16 v[44:47], v[20:23], v[204:207], v[44:47]
  v_and_b32 v8, v66, v4
  v_and_b32 v9, v66, v5
  v_and_b32 v10, v66, v6
  v_and_b32 v11, v66, v7
  v_and_b32 v12, v74, v4
  v_and_b32 v13, v74, v5
  v_and_b32 v14, v74, v6
  v_and_b32 v15, v74, v7
  s_nop 1
  v_mfma_f32_16x16x32_bf16 v[32:35], v[8:11], v[208:211], v[32:35]
  v_mfma_f32_16x16x32_bf16 v[40:43], v[8:11], v[212:215], v[40:43]
  v_mfma_f32_16x16x32_bf16 v[36:39], v[12:15], v[208:211], v[36:39]
  v_mfma_f32_16x16x32_bf16 v[44:47], v[12:15], v[212:215], v[44:47]
  v_and_b32 v16, v67, v4
  v_and_b32 v17, v67, v5
  v_and_b32 v18, v67, v6
  v_and_b32 v19, v67, v7
  v_and_b32 v20, v75, v4
  v_and_b32 v21, v75, v5
  v_and_b32 v22, v75, v6
  v_and_b32 v23, v75, v7
  s_nop 1
  v_mfma_f32_16x16x32_bf16 v[32:35], v[16:19], v[216:219], v[32:35]
  v_mfma_f32_16x16x32_bf16 v[40:43], v[16:19], v[220:223], v[40:43]
  v_mfma_f32_16x16x32_bf16 v[36:39], v[20:23], v[216:219], v[36:39]
  v_mfma_f32_16x16x32_bf16 v[44:47], v[20:23], v[220:223], v[44:47]
  v_and_b32 v8, v68, v4
  v_and_b32 v9, v68, v5
  v_and_b32 v10, v68, v6
  v_and_b32 v11, v68, v7
  v_and_b32 v12, v76, v4
  v_and_b32 v13, v76, v5
  v_and_b32 v14, v76, v6
  v_and_b32 v15, v76, v7
  s_nop 1
  v_mfma_f32_16x16x32_bf16 v[32:35], v[8:11], v[224:227], v[32:35]
  v_mfma_f32_16x16x32_bf16 v[40:43], v[8:11], v[228:231], v[40:43]
  v_mfma_f32_16x16x32_bf16 v[36:39], v[12:15], v[224:227], v[36:39]
  v_mfma_f32_16x16x32_bf16 v[44:47], v[12:15], v[228:231], v[44:47]
  v_and_b32 v16, v69, v4
  v_and_b32 v17, v69, v5
  v_and_b32 v18, v69, v6
  v_and_b32 v19, v69, v7
  v_and_b32 v20, v77, v4
  v_and_b32 v21, v77, v5
  v_and_b32 v22, v77, v6
  v_and_b32 v23, v77, v7
  s_nop 1
  v_mfma_f32_16x16x32_bf16 v[32:35], v[16:19], v[232:235], v[32:35]
  v_mfma_f32_16x16x32_bf16 v[40:43], v[16:19], v[236:239], v[40:43]
  v_mfma_f32_16x16x32_bf16 v[36:39], v[20:23], v[232:235], v[36:39]
  v_mfma_f32_16x16x32_bf16 v[44:47], v[20:23], v[236:239], v[44:47]
  v_and_b32 v8, v70, v4
  v_and_b32 v9, v70, v5
  v_and_b32 v10, v70, v6
  v_and_b32 v11, v70, v7
  v_and_b32 v12, v78, v4
  v_and_b32 v13, v78, v5
  v_and_b32 v14, v78, v6
  v_and_b32 v15, v78, v7
  s_nop 1
  v_mfma_f32_16x16x32_bf16 v[32:35], v[8:11], v[240:243], v[32:35]
  v_mfma_f32_16x16x32_bf16 v[40:43], v[8:11], v[244:247], v[40:43]
  v_mfma_f32_16x16x32_bf16 v[36:39], v[12:15], v[240:243], v[36:39]
  v_mfma_f32_16x16x32_bf16 v[44:47], v[12:15], v[244:247], v[44:47]
  v_and_b32 v16, v71, v4
  v_and_b32 v17, v71, v5
  v_and_b32 v18, v71, v6
  v_and_b32 v19, v71, v7
  v_and_b32 v20, v79, v4
  v_and_b32 v21, v79, v5
  v_and_b32 v22, v79, v6
  v_and_b32 v23, v79, v7
  s_nop 1
  v_mfma_f32_16x16x32_bf16 v[32:35], v[16:19], v[248:251], v[32:35]
  v_mfma_f32_16x16x32_bf16 v[40:43], v[16:19], v[252:255], v[40:43]
  v_mfma_f32_16x16x32_bf16 v[36:39], v[20:23], v[248:251], v[36:39]
  v_mfma_f32_16x16x32_bf16 v[44:47], v[20:23], v[252:255], v[44:47]
  s_nop 7
  v_mov_b32 v56, 131072
L_pw_p4:
  ds_read_b32 v57, v56
  s_waitcnt lgkmcnt(0)
  v_readfirstlane_b32 s51, v57
  s_cmp_ge_i32 s51, s52
  s_cbranch_scc1 L_pg_p4
  s_sub_u32 s34, s34, 1
  s_cbranch_scc1 L_exit
  s_sleep 4
  s_branch L_pw_p4
L_pg_p4:
  s_add_u32 s52, s52, 3
  buffer_load_dwordx4 v[192:195], v61, s[36:39], s48 offen nt
  buffer_load_dwordx4 v[196:199], v61, s[40:43], s48 offen nt
  s_add_u32 s48, s48, 14336
  buffer_load_dwordx4 v[200:203], v61, s[36:39], s48 offen nt
  buffer_load_dwordx4 v[204:207], v61, s[40:43], s48 offen nt
  s_add_u32 s48, s48, 14336
  buffer_load_dwordx4 v[208:211], v61, s[36:39], s48 offen nt
  buffer_load_dwordx4 v[212:215], v61, s[40:43], s48 offen nt
  s_add_u32 s48, s48, 14336
  buffer_load_dwordx4 v[216:219], v61, s[36:39], s48 offen nt
  buffer_load_dwordx4 v[220:223], v61, s[40:43], s48 offen nt
  s_add_u32 s48, s48, 14336
  buffer_load_dwordx4 v[224:227], v61, s[36:39], s48 offen nt
  buffer_load_dwordx4 v[228:231], v61, s[40:43], s48 offen nt
  s_add_u32 s48, s48, 14336
  buffer_load_dwordx4 v[232:235], v61, s[36:39], s48 offen nt
  buffer_load_dwordx4 v[236:239], v61, s[40:43], s48 offen nt
  s_add_u32 s48, s48, 14336
  buffer_load_dwordx4 v[240:243], v61, s[36:39], s48 offen nt
  buffer_load_dwordx4 v[244:247], v61, s[40:43], s48 offen nt
  s_add_u32 s48, s48, 14336
  buffer_load_dwordx4 v[248:251], v61, s[36:39], s48 offen nt
  buffer_load_dwordx4 v[252:255], v61, s[40:43], s48 offen nt
  s_add_u32 s48, s48, 14336
  v_add_u32 v62, 64, v62
  s_add_u32 s49, s49, 1
  s_cmp_lt_u32 s49, 8
  s_cbranch_scc1 L_ffn1
  s_waitcnt vmcnt(0)
  v_lshlrev_b32 v61, 10, v2
  v_lshl_add_u32 v61, v3, 4, v61
  s_lshl_b32 s48, s2, 17
  buffer_load_dwordx4 v[128:131], v61, s[44:47], s48 offen offset:0 nt
  buffer_load_dwordx4 v[132:135], v61, s[44:47], s48 offen offset:256 nt
  buffer_load_dwordx4 v[136:139], v61, s[44:47], s48 offen offset:512 nt
  buffer_load_dwordx4 v[140:143], v61, s[44:47], s48 offen offset:768 nt
  s_add_u32 s48, s48, 0x1000
  buffer_load_dwordx4 v[144:147], v61, s[44:47], s48 offen offset:0 nt
  buffer_load_dwordx4 v[148:151], v61, s[44:47], s48 offen offset:256 nt
  buffer_load_dwordx4 v[152:155], v61, s[44:47], s48 offen offset:512 nt
  buffer_load_dwordx4 v[156:159], v61, s[44:47], s48 offen offset:768 nt
  s_add_u32 s48, s48, 0x1000
  buffer_load_dwordx4 v[160:163], v61, s[44:47], s48 offen offset:0 nt
  buffer_load_dwordx4 v[164:167], v61, s[44:47], s48 offen offset:256 nt
  buffer_load_dwordx4 v[168:171], v61, s[44:47], s48 offen offset:512 nt
  buffer_load_dwordx4 v[172:175], v61, s[44:47], s48 offen offset:768 nt
  s_add_u32 s48, s48, 0x1000
  buffer_load_dwordx4 v[176:179], v61, s[44:47], s48 offen offset:0 nt
  buffer_load_dwordx4 v[180:183], v61, s[44:47], s48 offen offset:256 nt
  buffer_load_dwordx4 v[184:187], v61, s[44:47], s48 offen offset:512 nt
  buffer_load_dwordx4 v[188:191], v61, s[44:47], s48 offen offset:768 nt
  s_add_u32 s48, s48, 0x1000
  s_mov_b32 s50, 0xbfb8aa3b
  v_cvt_pk_bf16_f32 v32, v32, v32
  v_and_b32 v32, 0xffff0000, v32
  v_cvt_pk_bf16_f32 v40, v40, v40
  v_and_b32 v40, 0xffff0000, v40
  v_cvt_pk_bf16_f32 v33, v33, v33
  v_and_b32 v33, 0xffff0000, v33
  v_cvt_pk_bf16_f32 v41, v41, v41
  v_and_b32 v41, 0xffff0000, v41
  v_cvt_pk_bf16_f32 v34, v34, v34
  v_and_b32 v34, 0xffff0000, v34
  v_cvt_pk_bf16_f32 v42, v42, v42
  v_and_b32 v42, 0xffff0000, v42
  v_cvt_pk_bf16_f32 v35, v35, v35
  v_and_b32 v35, 0xffff0000, v35
  v_cvt_pk_bf16_f32 v43, v43, v43
  v_and_b32 v43, 0xffff0000, v43
  v_cvt_pk_bf16_f32 v36, v36, v36
  v_and_b32 v36, 0xffff0000, v36
  v_cvt_pk_bf16_f32 v44, v44, v44
  v_and_b32 v44, 0xffff0000, v44
  v_cvt_pk_bf16_f32 v37, v37, v37
  v_and_b32 v37, 0xffff0000, v37
  v_cvt_pk_bf16_f32 v45, v45, v45
  v_and_b32 v45, 0xffff0000, v45
  v_cvt_pk_bf16_f32 v38, v38, v38
  v_and_b32 v38, 0xffff0000, v38
  v_cvt_pk_bf16_f32 v46, v46, v46
  v_and_b32 v46, 0xffff0000, v46
  v_cvt_pk_bf16_f32 v39, v39, v39
  v_and_b32 v39, 0xffff0000, v39
  v_cvt_pk_bf16_f32 v47, v47, v47
  v_and_b32 v47, 0xffff0000, v47
  v_mul_f32 v64, s50, v32
  v_mul_f32 v65, s50, v33
  v_mul_f32 v66, s50, v34
  v_mul_f32 v67, s50, v35
  v_mul_f32 v68, s50, v36
  v_mul_f32 v69, s50, v37
  v_mul_f32 v70, s50, v38
  v_mul_f32 v71, s50, v39
  v_exp_f32 v64, v64
  v_exp_f32 v65, v65
  v_exp_f32 v66, v66
  v_exp_f32 v67, v67
  v_exp_f32 v68, v68
  v_exp_f32 v69, v69
  v_exp_f32 v70, v70
  v_exp_f32 v71, v71
  s_nop 0
  v_add_f32 v64, 1.0, v64
  v_add_f32 v65, 1.0, v65
  v_add_f32 v66, 1.0, v66
  v_add_f32 v67, 1.0, v67
  v_add_f32 v68, 1.0, v68
  v_add_f32 v69, 1.0, v69
  v_add_f32 v70, 1.0, v70
  v_add_f32 v71, 1.0, v71
  v_rcp_f32 v64, v64
  v_rcp_f32 v65, v65
  v_rcp_f32 v66, v66
  v_rcp_f32 v67, v67
  v_rcp_f32 v68, v68
  v_rcp_f32 v69, v69
  v_rcp_f32 v70, v70
  v_rcp_f32 v71, v71
  s_nop 0
  v_mul_f32 v64, v64, v32
  v_mul_f32 v65, v65, v33
  v_mul_f32 v66, v66, v34
  v_mul_f32 v67, v67, v35
  v_mul_f32 v68, v68, v36
  v_mul_f32 v69, v69, v37
  v_mul_f32 v70, v70, v38
  v_mul_f32 v71, v71, v39
  v_cvt_pk_bf16_f32 v64, v64, v64
  v_and_b32 v64, 0xffff0000, v64
  v_cvt_pk_bf16_f32 v65, v65, v65
  v_and_b32 v65, 0xffff0000, v65
  v_cvt_pk_bf16_f32 v66, v66, v66
  v_and_b32 v66, 0xffff0000, v66
  v_cvt_pk_bf16_f32 v67, v67, v67
  v_and_b32 v67, 0xffff0000, v67
  v_cvt_pk_bf16_f32 v68, v68, v68
  v_and_b32 v68, 0xffff0000, v68
  v_cvt_pk_bf16_f32 v69, v69, v69
  v_and_b32 v69, 0xffff0000, v69
  v_cvt_pk_bf16_f32 v70, v70, v70
  v_and_b32 v70, 0xffff0000, v70
  v_cvt_pk_bf16_f32 v71, v71, v71
  v_and_b32 v71, 0xffff0000, v71
  v_mul_f32 v64, v64, v40
  v_mul_f32 v65, v65, v41
  v_mul_f32 v66, v66, v42
  v_mul_f32 v67, v67, v43
  v_mul_f32 v68, v68, v44
  v_mul_f32 v69, v69, v45
  v_mul_f32 v70, v70, v46
  v_mul_f32 v71, v71, v47
  v_cvt_pk_bf16_f32 v64, v64, v64
  v_cvt_pk_bf16_f32 v65, v65, v65
  v_cvt_pk_bf16_f32 v66, v66, v66
  v_cvt_pk_bf16_f32 v67, v67, v67
  v_cvt_pk_bf16_f32 v68, v68, v68
  v_cvt_pk_bf16_f32 v69, v69, v69
  v_cvt_pk_bf16_f32 v70, v70, v70
  v_cvt_pk_bf16_f32 v71, v71, v71
  v_lshrrev_b32 v62, 1, v2
  v_lshlrev_b32 v62, 9, v62
  v_lshl_add_u32 v62, v3, 3, v62
  v_and_b32 v63, 1, v2
  v_lshl_add_u32 v62, v63, 2, v62
  v_add_u32 v62, 155648, v62
  ds_write_b32 v62, v64 offset:0
  ds_write_b32 v62, v65 offset:128
  ds_write_b32 v62, v66 offset:256
  ds_write_b32 v62, v67 offset:384
  ds_write_b32 v62, v68 offset:1024
  ds_write_b32 v62, v69 offset:1152
  ds_write_b32 v62, v70 offset:1280
  ds_write_b32 v62, v71 offset:1408
  v_lshrrev_b32 v62, 3, v3
  v_lshlrev_b32 v62, 9, v62
  v_lshl_add_u32 v62, v2, 7, v62
  v_add_u32 v62, 155648, v62
  v_mov_b32 v80, 0
  v_mov_b32 v81, 0
  v_mov_b32 v82, 0
  v_mov_b32 v83, 0
  v_mov_b32 v84, 0
  v_mov_b32 v85, 0
  v_mov_b32 v86, 0
  v_mov_b32 v87, 0
  v_mov_b32 v88, 0
  v_mov_b32 v89, 0
  v_mov_b32 v90, 0
  v_mov_b32 v91, 0
  v_mov_b32 v92, 0
  v_mov_b32 v93, 0
  v_mov_b32 v94, 0
  v_mov_b32 v95, 0
  v_mov_b32 v96, 0
  v_mov_b32 v97, 0
  v_mov_b32 v98, 0
  v_mov_b32 v99, 0
  v_mov_b32 v100, 0
  v_mov_b32 v101, 0
  v_mov_b32 v102, 0
  v_mov_b32 v103, 0
  v_mov_b32 v104, 0
  v_mov_b32 v105, 0
  v_mov_b32 v106, 0
  v_mov_b32 v107, 0
  v_mov_b32 v108, 0
  v_mov_b32 v109, 0
  v_mov_b32 v110, 0
  v_mov_b32 v111, 0
  v_mov_b32 v56, 131072
L_pw_p5:
  ds_read_b32 v57, v56
  s_waitcnt lgkmcnt(0)
  v_readfirstlane_b32 s51, v57
  s_cmp_ge_i32 s51, s52
  s_cbranch_scc1 L_pg_p5
  s_sub_u32 s34, s34, 1
  s_cbranch_scc1 L_exit
  s_sleep 4
  s_branch L_pw_p5
L_pg_p5:
  s_add_u32 s52, s52, 3
  buffer_load_dwordx4 v[192:195], v61, s[44:47], s48 offen offset:0 nt
  buffer_load_dwordx4 v[196:199], v61, s[44:47], s48 offen offset:256 nt
  buffer_load_dwordx4 v[200:203], v61, s[44:47], s48 offen offset:512 nt
  buffer_load_dwordx4 v[204:207], v61, s[44:47], s48 offen offset:768 nt
  s_add_u32 s48, s48, 0x1000
  buffer_load_dwordx4 v[208:211], v61, s[44:47], s48 offen offset:0 nt
  buffer_load_dwordx4 v[212:215], v61, s[44:47], s48 offen offset:256 nt
  buffer_load_dwordx4 v[216:219], v61, s[44:47], s48 offen offset:512 nt
  buffer_load_dwordx4 v[220:223], v61, s[44:47], s48 offen offset:768 nt
  s_add_u32 s48, s48, 0x1000
  buffer_load_dwordx4 v[224:227], v61, s[44:47], s48 offen offset:0 nt
  buffer_load_dwordx4 v[228:231], v61, s[44:47], s48 offen offset:256 nt
  buffer_load_dwordx4 v[232:235], v61, s[44:47], s48 offen offset:512 nt
  buffer_load_dwordx4 v[236:239], v61, s[44:47], s48 offen offset:768 nt
  s_add_u32 s48, s48, 0x1000
  buffer_load_dwordx4 v[240:243], v61, s[44:47], s48 offen offset:0 nt
  buffer_load_dwordx4 v[244:247], v61, s[44:47], s48 offen offset:256 nt
  buffer_load_dwordx4 v[248:251], v61, s[44:47], s48 offen offset:512 nt
  buffer_load_dwordx4 v[252:255], v61, s[44:47], s48 offen offset:768 nt
  s_add_u32 s48, s48, 0x1000
  s_mov_b32 s49, 0
L_ffn2:
  ds_read_b128 v[64:67], v62 offset:0
  ds_read_b128 v[68:71], v62 offset:1024
  s_waitcnt vmcnt(16) lgkmcnt(0)
  v_and_b32 v8, v64, v4
  v_and_b32 v9, v64, v5
  v_and_b32 v10, v64, v6
  v_and_b32 v11, v64, v7
  v_and_b32 v12, v68, v4
  v_and_b32 v13, v68, v5
  v_and_b32 v14, v68, v6
  v_and_b32 v15, v68, v7
  s_nop 1
  v_mfma_f32_16x16x32_bf16 v[80:83], v[8:11], v[128:131], v[80:83]
  v_mfma_f32_16x16x32_bf16 v[84:87], v[12:15], v[128:131], v[84:87]
  v_mfma_f32_16x16x32_bf16 v[88:91], v[8:11], v[132:135], v[88:91]
  v_mfma_f32_16x16x32_bf16 v[92:95], v[12:15], v[132:135], v[92:95]
  v_mfma_f32_16x16x32_bf16 v[96:99], v[8:11], v[136:139], v[96:99]
  v_mfma_f32_16x16x32_bf16 v[100:103], v[12:15], v[136:139], v[100:103]
  v_mfma_f32_16x16x32_bf16 v[104:107], v[8:11], v[140:143], v[104:107]
  v_mfma_f32_16x16x32_bf16 v[108:111], v[12:15], v[140:143], v[108:111]
  v_and_b32 v16, v65, v4
  v_and_b32 v17, v65, v5
  v_and_b32 v18, v65, v6
  v_and_b32 v19, v65, v7
  v_and_b32 v20, v69, v4
  v_and_b32 v21, v69, v5
  v_and_b32 v22, v69, v6
  v_and_b32 v23, v69, v7
  s_nop 1
  v_mfma_f32_16x16x32_bf16 v[80:83], v[16:19], v[144:147], v[80:83]
  v_mfma_f32_16x16x32_bf16 v[84:87], v[20:23], v[144:147], v[84:87]
  v_mfma_f32_16x16x32_bf16 v[88:91], v[16:19], v[148:151], v[88:91]
  v_mfma_f32_16x16x32_bf16 v[92:95], v[20:23], v[148:151], v[92:95]
  v_mfma_f32_16x16x32_bf16 v[96:99], v[16:19], v[152:155], v[96:99]
  v_mfma_f32_16x16x32_bf16 v[100:103], v[20:23], v[152:155], v[100:103]
  v_mfma_f32_16x16x32_bf16 v[104:107], v[16:19], v[156:159], v[104:107]
  v_mfma_f32_16x16x32_bf16 v[108:111], v[20:23], v[156:159], v[108:111]
  v_and_b32 v8, v66, v4
  v_and_b32 v9, v66, v5
  v_and_b32 v10, v66, v6
  v_and_b32 v11, v66, v7
  v_and_b32 v12, v70, v4
  v_and_b32 v13, v70, v5
  v_and_b32 v14, v70, v6
  v_and_b32 v15, v70, v7
  s_nop 1
  v_mfma_f32_16x16x32_bf16 v[80:83], v[8:11], v[160:163], v[80:83]
  v_mfma_f32_16x16x32_bf16 v[84:87], v[12:15], v[160:163], v[84:87]
  v_mfma_f32_16x16x32_bf16 v[88:91], v[8:11], v[164:167], v[88:91]
  v_mfma_f32_16x16x32_bf16 v[92:95], v[12:15], v[164:167], v[92:95]
  v_mfma_f32_16x16x32_bf16 v[96:99], v[8:11], v[168:171], v[96:99]
  v_mfma_f32_16x16x32_bf16 v[100:103], v[12:15], v[168:171], v[100:103]
  v_mfma_f32_16x16x32_bf16 v[104:107], v[8:11], v[172:175], v[104:107]
  v_mfma_f32_16x16x32_bf16 v[108:111], v[12:15], v[172:175], v[108:111]
  v_and_b32 v16, v67, v4
  v_and_b32 v17, v67, v5
  v_and_b32 v18, v67, v6
  v_and_b32 v19, v67, v7
  v_and_b32 v20, v71, v4
  v_and_b32 v21, v71, v5
  v_and_b32 v22, v71, v6
  v_and_b32 v23, v71, v7
  s_nop 1
  v_mfma_f32_16x16x32_bf16 v[80:83], v[16:19], v[176:179], v[80:83]
  v_mfma_f32_16x16x32_bf16 v[84:87], v[20:23], v[176:179], v[84:87]
  v_mfma_f32_16x16x32_bf16 v[88:91], v[16:19], v[180:183], v[88:91]
  v_mfma_f32_16x16x32_bf16 v[92:95], v[20:23], v[180:183], v[92:95]
  v_mfma_f32_16x16x32_bf16 v[96:99], v[16:19], v[184:187], v[96:99]
  v_mfma_f32_16x16x32_bf16 v[100:103], v[20:23], v[184:187], v[100:103]
  v_mfma_f32_16x16x32_bf16 v[104:107], v[16:19], v[188:191], v[104:107]
  v_mfma_f32_16x16x32_bf16 v[108:111], v[20:23], v[188:191], v[108:111]
  s_nop 7
  s_cmp_ge_u32 s49, 3
  s_cbranch_scc1 L_ffn2skip0
  v_mov_b32 v56, 131072
L_pw_p6:
  ds_read_b32 v57, v56
  s_waitcnt lgkmcnt(0)
  v_readfirstlane_b32 s51, v57
  s_cmp_ge_i32 s51, s52
  s_cbranch_scc1 L_pg_p6
  s_sub_u32 s34, s34, 1
  s_cbranch_scc1 L_exit
  s_sleep 4
  s_branch L_pw_p6
L_pg_p6:
  s_add_u32 s52, s52, 3
  buffer_load_dwordx4 v[128:131], v61, s[44:47], s48 offen offset:0 nt
  buffer_load_dwordx4 v[132:135], v61, s[44:47], s48 offen offset:256 nt
  buffer_load_dwordx4 v[136:139], v61, s[44:47], s48 offen offset:512 nt
  buffer_load_dwordx4 v[140:143], v61, s[44:47], s48 offen offset:768 nt
  s_add_u32 s48, s48, 0x1000
  buffer_load_dwordx4 v[144:147], v61, s[44:47], s48 offen offset:0 nt
  buffer_load_dwordx4 v[148:151], v61, s[44:47], s48 offen offset:256 nt
  buffer_load_dwordx4 v[152:155], v61, s[44:47], s48 offen offset:512 nt
  buffer_load_dwordx4 v[156:159], v61, s[44:47], s48 offen offset:768 nt
  s_add_u32 s48, s48, 0x1000
  buffer_load_dwordx4 v[160:163], v61, s[44:47], s48 offen offset:0 nt
  buffer_load_dwordx4 v[164:167], v61, s[44:47], s48 offen offset:256 nt
  buffer_load_dwordx4 v[168:171], v61, s[44:47], s48 offen offset:512 nt
  buffer_load_dwordx4 v[172:175], v61, s[44:47], s48 offen offset:768 nt
  s_add_u32 s48, s48, 0x1000
  buffer_load_dwordx4 v[176:179], v61, s[44:47], s48 offen offset:0 nt
  buffer_load_dwordx4 v[180:183], v61, s[44:47], s48 offen offset:256 nt
  buffer_load_dwordx4 v[184:187], v61, s[44:47], s48 offen offset:512 nt
  buffer_load_dwordx4 v[188:191], v61, s[44:47], s48 offen offset:768 nt
  s_add_u32 s48, s48, 0x1000
  s_branch L_ffn2cont0
L_ffn2skip0:
  s_waitcnt vmcnt(0)
L_ffn2cont0:
  ds_read_b128 v[64:67], v62 offset:16
  ds_read_b128 v[68:71], v62 offset:1040
  s_waitcnt vmcnt(16) lgkmcnt(0)
  v_and_b32 v8, v64, v4
  v_and_b32 v9, v64, v5
  v_and_b32 v10, v64, v6
  v_and_b32 v11, v64, v7
  v_and_b32 v12, v68, v4
  v_and_b32 v13, v68, v5
  v_and_b32 v14, v68, v6
  v_and_b32 v15, v68, v7
  s_nop 1
  v_mfma_f32_16x16x32_bf16 v[80:83], v[8:11], v[192:195], v[80:83]
  v_mfma_f32_16x16x32_bf16 v[84:87], v[12:15], v[192:195], v[84:87]
  v_mfma_f32_16x16x32_bf16 v[88:91], v[8:11], v[196:199], v[88:91]
  v_mfma_f32_16x16x32_bf16 v[92:95], v[12:15], v[196:199], v[92:95]
  v_mfma_f32_16x16x32_bf16 v[96:99], v[8:11], v[200:203], v[96:99]
  v_mfma_f32_16x16x32_bf16 v[100:103], v[12:15], v[200:203], v[100:103]
  v_mfma_f32_16x16x32_bf16 v[104:107], v[8:11], v[204:207], v[104:107]
  v_mfma_f32_16x16x32_bf16 v[108:111], v[12:15], v[204:207], v[108:111]
  v_and_b32 v16, v65, v4
  v_and_b32 v17, v65, v5
  v_and_b32 v18, v65, v6
  v_and_b32 v19, v65, v7
  v_and_b32 v20, v69, v4
  v_and_b32 v21, v69, v5
  v_and_b32 v22, v69, v6
  v_and_b32 v23, v69, v7
  s_nop 1
  v_mfma_f32_16x16x32_bf16 v[80:83], v[16:19], v[208:211], v[80:83]
  v_mfma_f32_16x16x32_bf16 v[84:87], v[20:23], v[208:211], v[84:87]
  v_mfma_f32_16x16x32_bf16 v[88:91], v[16:19], v[212:215], v[88:91]
  v_mfma_f32_16x16x32_bf16 v[92:95], v[20:23], v[212:215], v[92:95]
  v_mfma_f32_16x16x32_bf16 v[96:99], v[16:19], v[216:219], v[96:99]
  v_mfma_f32_16x16x32_bf16 v[100:103], v[20:23], v[216:219], v[100:103]
  v_mfma_f32_16x16x32_bf16 v[104:107], v[16:19], v[220:223], v[104:107]
  v_mfma_f32_16x16x32_bf16 v[108:111], v[20:23], v[220:223], v[108:111]
  v_and_b32 v8, v66, v4
  v_and_b32 v9, v66, v5
  v_and_b32 v10, v66, v6
  v_and_b32 v11, v66, v7
  v_and_b32 v12, v70, v4
  v_and_b32 v13, v70, v5
  v_and_b32 v14, v70, v6
  v_and_b32 v15, v70, v7
  s_nop 1
  v_mfma_f32_16x16x32_bf16 v[80:83], v[8:11], v[224:227], v[80:83]
  v_mfma_f32_16x16x32_bf16 v[84:87], v[12:15], v[224:227], v[84:87]
  v_mfma_f32_16x16x32_bf16 v[88:91], v[8:11], v[228:231], v[88:91]
  v_mfma_f32_16x16x32_bf16 v[92:95], v[12:15], v[228:231], v[92:95]
  v_mfma_f32_16x16x32_bf16 v[96:99], v[8:11], v[232:235], v[96:99]
  v_mfma_f32_16x16x32_bf16 v[100:103], v[12:15], v[232:235], v[100:103]
  v_mfma_f32_16x16x32_bf16 v[104:107], v[8:11], v[236:239], v[104:107]
  v_mfma_f32_16x16x32_bf16 v[108:111], v[12:15], v[236:239], v[108:111]
  v_and_b32 v16, v67, v4
  v_and_b32 v17, v67, v5
  v_and_b32 v18, v67, v6
  v_and_b32 v19, v67, v7
  v_and_b32 v20, v71, v4
  v_and_b32 v21, v71, v5
  v_and_b32 v22, v71, v6
  v_and_b32 v23, v71, v7
  s_nop 1
  v_mfma_f32_16x16x32_bf16 v[80:83], v[16:19], v[240:243], v[80:83]
  v_mfma_f32_16x16x32_bf16 v[84:87], v[20:23], v[240:243], v[84:87]
  v_mfma_f32_16x16x32_bf16 v[88:91], v[16:19], v[244:247], v[88:91]
  v_mfma_f32_16x16x32_bf16 v[92:95], v[20:23], v[244:247], v[92:95]
  v_mfma_f32_16x16x32_bf16 v[96:99], v[16:19], v[248:251], v[96:99]
  v_mfma_f32_16x16x32_bf16 v[100:103], v[20:23], v[248:251], v[100:103]
  v_mfma_f32_16x16x32_bf16 v[104:107], v[16:19], v[252:255], v[104:107]
  v_mfma_f32_16x16x32_bf16 v[108:111], v[20:23], v[252:255], v[108:111]
  s_nop 7
  s_cmp_ge_u32 s49, 3
  s_cbranch_scc1 L_ffn2skip1
  v_mov_b32 v56, 131072
L_pw_p7:
  ds_read_b32 v57, v56
  s_waitcnt lgkmcnt(0)
  v_readfirstlane_b32 s51, v57
  s_cmp_ge_i32 s51, s52
  s_cbranch_scc1 L_pg_p7
  s_sub_u32 s34, s34, 1
  s_cbranch_scc1 L_exit
  s_sleep 4
  s_branch L_pw_p7
L_pg_p7:
  s_add_u32 s52, s52, 3
  buffer_load_dwordx4 v[192:195], v61, s[44:47], s48 offen offset:0 nt
  buffer_load_dwordx4 v[196:199], v61, s[44:47], s48 offen offset:256 nt
  buffer_load_dwordx4 v[200:203], v61, s[44:47], s48 offen offset:512 nt
  buffer_load_dwordx4 v[204:207], v61, s[44:47], s48 offen offset:768 nt
  s_add_u32 s48, s48, 0x1000
  buffer_load_dwordx4 v[208:211], v61, s[44:47], s48 offen offset:0 nt
  buffer_load_dwordx4 v[212:215], v61, s[44:47], s48 offen offset:256 nt
  buffer_load_dwordx4 v[216:219], v61, s[44:47], s48 offen offset:512 nt
  buffer_load_dwordx4 v[220:223], v61, s[44:47], s48 offen offset:768 nt
  s_add_u32 s48, s48, 0x1000
  buffer_load_dwordx4 v[224:227], v61, s[44:47], s48 offen offset:0 nt
  buffer_load_dwordx4 v[228:231], v61, s[44:47], s48 offen offset:256 nt
  buffer_load_dwordx4 v[232:235], v61, s[44:47], s48 offen offset:512 nt
  buffer_load_dwordx4 v[236:239], v61, s[44:47], s48 offen offset:768 nt
  s_add_u32 s48, s48, 0x1000
  buffer_load_dwordx4 v[240:243], v61, s[44:47], s48 offen offset:0 nt
  buffer_load_dwordx4 v[244:247], v61, s[44:47], s48 offen offset:256 nt
  buffer_load_dwordx4 v[248:251], v61, s[44:47], s48 offen offset:512 nt
  buffer_load_dwordx4 v[252:255], v61, s[44:47], s48 offen offset:768 nt
  s_add_u32 s48, s48, 0x1000
  s_branch L_ffn2cont1
L_ffn2skip1:
  s_waitcnt vmcnt(0)
L_ffn2cont1:
  v_add_u32 v62, 32, v62
  s_add_u32 s49, s49, 1
  s_cmp_lt_u32 s49, 4
  s_cbranch_scc1 L_ffn2
  s_lshl_b32 s37, s2, 13
  s_add_u32 s37, s37, 557056
  v_lshrrev_b32 v61, 1, v2
  v_lshlrev_b32 v61, 11, v61
  v_lshl_add_u32 v61, v3, 5, v61
  v_and_b32 v63, 1, v2
  v_lshl_add_u32 v61, v63, 4, v61
  v_add_u32 v61, s37, v61
  v_add_u32 v62, 0x1000, v61
  global_store_dwordx4 v61, v[80:83], s[26:27] offset:0 sc1
  global_store_dwordx4 v62, v[84:87], s[26:27] offset:0 sc1
  global_store_dwordx4 v61, v[88:91], s[26:27] offset:512 sc1
  global_store_dwordx4 v62, v[92:95], s[26:27] offset:512 sc1
  global_store_dwordx4 v61, v[96:99], s[26:27] offset:1024 sc1
  global_store_dwordx4 v62, v[100:103], s[26:27] offset:1024 sc1
  global_store_dwordx4 v61, v[104:107], s[26:27] offset:1536 sc1
  global_store_dwordx4 v62, v[108:111], s[26:27] offset:1536 sc1
  s_lshl_b32 s37, s2, 2
  v_mov_b32 v14, s37
  v_mov_b32 v15, 1
  s_waitcnt vmcnt(0)
  s_mov_b64 exec, 1
  global_store_dword v14, v15, s[24:25] offset:16 sc1
  s_mov_b64 exec, -1
L_noffn:
  v_mov_b32 v56, 131072
L_pw_c:
  ds_read_b32 v57, v56
  s_waitcnt lgkmcnt(0)
  v_readfirstlane_b32 s51, v57
  s_cmp_ge_i32 s51, 40
  s_cbranch_scc1 L_pg_c
  s_sub_u32 s34, s34, 1
  s_cbranch_scc1 L_exit
  s_sleep 32
  s_branch L_pw_c
L_pg_c:
  v_lshlrev_b32 v12, 2, v0
  s_mov_b64 exec, 15
L_fln:
  global_load_dword v13, v12, s[24:25] sc1
  s_waitcnt vmcnt(0)
  v_cmp_ne_u32 vcc, 1, v13
  s_cmp_eq_u64 vcc, 0
  s_cbranch_scc1 L_flokn
  s_sub_u32 s34, s34, 1
  s_cbranch_scc1 L_exit
  s_sleep 16
  s_branch L_fln
L_flokn:
  s_mov_b64 exec, -1
  s_sub_u32 s40, s2, 64
  s_cmp_lt_u32 s40, 64
  s_cbranch_scc1 L_red
  v_mov_b32 v56, 131072
L_pw_bna:
  ds_read_b32 v57, v56
  s_waitcnt lgkmcnt(0)
  v_readfirstlane_b32 s51, v57
  s_cmp_ge_i32 s51, 96
  s_cbranch_scc1 L_pg_bna
  s_sub_u32 s34, s34, 1
  s_cbranch_scc1 L_exit
  s_sleep 8
  s_branch L_pw_bna
L_pg_bna:
  v_mul_u32_u24 v12, 35, v0
  v_xor_b32 v12, s33, v12
  v_and_b32 v12, 0xff, v12
  v_lshlrev_b32 v12, 7, v12
  v_add_u32 v12, 524288, v12
  v_mov_b32 v14, 132864
  s_mov_b32 s43, 0
  s_mov_b32 s44, 0
  s_cmp_lt_u32 s2, 14
  s_cselect_b32 s45, 24, 20
L_bcna:
  ds_read_b32 v57, v56
  ds_read_b32 v13, v14
  ds_read_b64 v[44:45], v14 offset:128
  s_cmp_lg_u32 s44, 0
  s_cbranch_scc1 L_bcnna
  s_mov_b64 exec, 255
  global_load_dword v15, v12, s[26:27] offset:0 sc1
  s_waitcnt vmcnt(0)
  v_cmp_ne_u32 vcc, -1, v15
  s_mov_b64 exec, -1
  s_bcnt1_i32_b64 s37, vcc
  s_cmp_lt_u32 s37, 4
  s_cselect_b32 s45, 0, s45
  s_cbranch_scc1 L_bcnna
  ds_read_b32 v57, v56
  s_waitcnt lgkmcnt(0)
  v_readfirstlane_b32 s51, v57
  s_mov_b32 s44, 1
  s_sub_i32 s38, 105, s51
  s_sub_u32 s37, s37, 3
  s_lshr_b32 s37, s37, 1
  s_add_u32 s38, s38, s37
  s_max_i32 s38, s38, 0
  s_min_i32 s38, s38, 9
  s_mul_i32 s38, s38, 6
  s_mov_b32 s46, 374420625
  s_mov_b32 s47, 186940854
  s_lshr_b64 s[46:47], s[46:47], s38
  s_and_b32 s38, s46, 63
  s_max_u32 s38, s38, s45
  v_mov_b32 v15, s38
  ds_write_b32 v14, v15 offset:4
L_bcnna:
  s_waitcnt lgkmcnt(0)
  s_cmp_lg_u32 s43, 0
  s_cbranch_scc1 L_bcpna
  v_readfirstlane_b32 s51, v57
  v_readfirstlane_b32 s36, v13
  s_cmp_lt_i32 s51, 100
  s_cbranch_scc1 L_bcpna
  s_cmp_eq_u32 s36, 0
  s_cbranch_scc1 L_bcpna
  v_mov_b32 v46, v44
  v_mov_b32 v47, v45
  s_mov_b64 exec, 0xff
  global_store_dwordx4 v59, v[44:47], s[26:27] sc1
  s_mov_b64 exec, -1
  s_mov_b32 s43, 1
L_bcpna:
  s_and_b32 s36, s43, s44
  s_cbranch_scc1 L_bcdonena
  s_sub_u32 s34, s34, 1
  s_cbranch_scc1 L_exit
  s_sleep 12
  s_branch L_bcna
L_bcdonena:
  s_endpgm
L_red:
  v_mov_b32 v56, 131072
L_pw_bra:
  ds_read_b32 v57, v56
  s_waitcnt lgkmcnt(0)
  v_readfirstlane_b32 s51, v57
  s_cmp_ge_i32 s51, 96
  s_cbranch_scc1 L_pg_bra
  s_sub_u32 s34, s34, 1
  s_cbranch_scc1 L_exit
  s_sleep 8
  s_branch L_pw_bra
L_pg_bra:
  v_mul_u32_u24 v12, 35, v0
  v_xor_b32 v12, s33, v12
  v_and_b32 v12, 0xff, v12
  v_lshlrev_b32 v12, 7, v12
  v_add_u32 v12, 524288, v12
  v_mov_b32 v14, 132864
  s_mov_b32 s43, 0
  s_mov_b32 s44, 0
  s_cmp_lt_u32 s2, 14
  s_cselect_b32 s45, 24, 20
L_bcra:
  ds_read_b32 v57, v56
  ds_read_b32 v13, v14
  ds_read_b64 v[44:45], v14 offset:128
  s_cmp_lg_u32 s44, 0
  s_cbranch_scc1 L_bcnra
  s_mov_b64 exec, 255
  global_load_dword v15, v12, s[26:27] offset:0 sc1
  s_waitcnt vmcnt(0)
  v_cmp_ne_u32 vcc, -1, v15
  s_mov_b64 exec, -1
  s_bcnt1_i32_b64 s37, vcc
  s_cmp_lt_u32 s37, 4
  s_cselect_b32 s45, 0, s45
  s_cbranch_scc1 L_bcnra
  ds_read_b32 v57, v56
  s_waitcnt lgkmcnt(0)
  v_readfirstlane_b32 s51, v57
  s_mov_b32 s44, 1
  s_sub_i32 s38, 105, s51
  s_sub_u32 s37, s37, 3
  s_lshr_b32 s37, s37, 1
  s_add_u32 s38, s38, s37
  s_max_i32 s38, s38, 0
  s_min_i32 s38, s38, 9
  s_mul_i32 s38, s38, 6
  s_mov_b32 s46, 374420625
  s_mov_b32 s47, 186940854
  s_lshr_b64 s[46:47], s[46:47], s38
  s_and_b32 s38, s46, 63
  s_max_u32 s38, s38, s45
  v_mov_b32 v15, s38
  ds_write_b32 v14, v15 offset:4
L_bcnra:
  s_waitcnt lgkmcnt(0)
  s_cmp_lg_u32 s43, 0
  s_cbranch_scc1 L_bcpra
  v_readfirstlane_b32 s51, v57
  v_readfirstlane_b32 s36, v13
  s_cmp_lt_i32 s51, 100
  s_cbranch_scc1 L_bcpra
  s_cmp_eq_u32 s36, 0
  s_cbranch_scc1 L_bcpra
  v_mov_b32 v46, v44
  v_mov_b32 v47, v45
  s_mov_b64 exec, 0xff
  global_store_dwordx4 v59, v[44:47], s[26:27] sc1
  s_mov_b64 exec, -1
  s_mov_b32 s43, 1
L_bcpra:
  s_and_b32 s36, s43, s44
  s_cbranch_scc1 L_bcdonera
  s_sub_u32 s34, s34, 1
  s_cbranch_scc1 L_exit
  s_sleep 12
  s_branch L_bcra
L_bcdonera:
  v_mov_b32 v56, 131072
L_pw_r:
  ds_read_b32 v57, v56
  s_waitcnt lgkmcnt(0)
  v_readfirstlane_b32 s51, v57
  s_cmp_ge_i32 s51, 110
  s_cbranch_scc1 L_pg_r
  s_sub_u32 s34, s34, 1
  s_cbranch_scc1 L_exit
  s_sleep 8
  s_branch L_pw_r
L_pg_r:
  v_lshlrev_b32 v12, 2, v0
  s_mov_b64 exec, 262143
L_flr:
  global_load_dword v13, v12, s[24:25] sc1
  s_waitcnt vmcnt(0)
  v_cmp_ne_u32 vcc, 1, v13
  s_cmp_eq_u64 vcc, 0
  s_cbranch_scc1 L_flokr
  s_sub_u32 s34, s34, 1
  s_cbranch_scc1 L_exit
  s_sleep 16
  s_branch L_flr
L_flokr:
  s_mov_b64 exec, -1
  s_lshr_b32 s41, s40, 4
  s_and_b32 s42, s40, 15
  v_lshrrev_b32 v4, 3, v0
  v_and_b32 v5, 7, v0
  s_lshl_b32 s36, s40, 6
  v_lshl_add_u32 v61, v5, 3, s36
  global_load_dwordx2 v[24:25], v61, s[4:5]
  global_load_dwordx2 v[30:31], v61, s[22:23]
  s_lshl_b32 s36, s41, 11
  s_lshl_b32 s37, s42, 7
  s_add_u32 s36, s36, s37
  s_add_u32 s36, s36, 557056
  v_lshlrev_b32 v6, 13, v4
  v_lshl_add_u32 v6, v5, 4, v6
  v_add_u32 v6, s36, v6
  v_add_u32 v7, 0x10000, v6
  s_lshl_b32 s36, s41, 13
  s_add_u32 s36, s36, 524288
  v_lshl_add_u32 v8, v0, 7, s36
  v_mov_b32 v20, 0
  v_mov_b32 v21, 0
  v_mov_b32 v22, 0
  v_mov_b32 v23, 0
  global_load_dwordx4 v[16:19], v6, s[26:27] sc1
  s_mov_b32 exec_hi, 0xffff
  global_load_dwordx4 v[20:23], v7, s[26:27] sc1
  s_mov_b64 exec, -1
  s_waitcnt vmcnt(0)
  v_add_f32 v16, v16, v20
  v_add_f32 v17, v17, v21
  v_add_f32 v18, v18, v22
  v_add_f32 v19, v19, v23
  s_nop 1
  v_add_f32_dpp v16, v16, v16 row_ror:8 row_mask:0xf bank_mask:0xf
  v_add_f32_dpp v17, v17, v17 row_ror:8 row_mask:0xf bank_mask:0xf
  v_add_f32_dpp v18, v18, v18 row_ror:8 row_mask:0xf bank_mask:0xf
  v_add_f32_dpp v19, v19, v19 row_ror:8 row_mask:0xf bank_mask:0xf
  v_mov_b32 v20, v16
  v_mov_b32 v21, v17
  v_mov_b32 v22, v18
  v_mov_b32 v23, v19
  s_nop 1
  v_permlane16_swap_b32 v16, v20
  v_permlane16_swap_b32 v17, v21
  v_permlane16_swap_b32 v18, v22
  v_permlane16_swap_b32 v19, v23
  s_nop 1
  v_add_f32 v16, v16, v20
  v_add_f32 v17, v17, v21
  v_add_f32 v18, v18, v22
  v_add_f32 v19, v19, v23
  v_mov_b32 v20, v16
  v_mov_b32 v21, v17
  v_mov_b32 v22, v18
  v_mov_b32 v23, v19
  s_nop 1
  v_permlane32_swap_b32 v16, v20
  v_permlane32_swap_b32 v17, v21
  v_permlane32_swap_b32 v18, v22
  v_permlane32_swap_b32 v19, v23
  s_nop 1
  v_add_f32 v16, v16, v20
  v_add_f32 v17, v17, v21
  v_add_f32 v18, v18, v22
  v_add_f32 v19, v19, v23
  s_mov_b32 s50, 0xbfb8aa3b
  v_cvt_pk_bf16_f32 v16, v16, v16
  v_and_b32 v16, 0xffff0000, v16
  v_cvt_pk_bf16_f32 v17, v17, v17
  v_and_b32 v17, 0xffff0000, v17
  v_cvt_pk_bf16_f32 v18, v18, v18
  v_and_b32 v18, 0xffff0000, v18
  v_cvt_pk_bf16_f32 v19, v19, v19
  v_and_b32 v19, 0xffff0000, v19
  v_mul_f32 v20, s50, v16
  v_mul_f32 v21, s50, v17
  v_mul_f32 v22, s50, v18
  v_mul_f32 v23, s50, v19
  v_exp_f32 v20, v20
  v_exp_f32 v21, v21
  v_exp_f32 v22, v22
  v_exp_f32 v23, v23
  s_nop 0
  v_add_f32 v20, 1.0, v20
  v_add_f32 v21, 1.0, v21
  v_add_f32 v22, 1.0, v22
  v_add_f32 v23, 1.0, v23
  v_rcp_f32 v20, v20
  v_rcp_f32 v21, v21
  v_rcp_f32 v22, v22
  v_rcp_f32 v23, v23
  s_nop 0
  v_mul_f32 v16, v16, v20
  v_mul_f32 v17, v17, v21
  v_mul_f32 v18, v18, v22
  v_mul_f32 v19, v19, v23
  v_cvt_pk_bf16_f32 v16, v16, v16
  v_and_b32 v16, 0xffff0000, v16
  v_cvt_pk_bf16_f32 v17, v17, v17
  v_and_b32 v17, 0xffff0000, v17
  v_cvt_pk_bf16_f32 v18, v18, v18
  v_and_b32 v18, 0xffff0000, v18
  v_cvt_pk_bf16_f32 v19, v19, v19
  v_and_b32 v19, 0xffff0000, v19
  v_lshlrev_b32 v26, 16, v24
  v_and_b32 v27, 0xffff0000, v24
  v_lshlrev_b32 v28, 16, v25
  v_and_b32 v29, 0xffff0000, v25
  s_lshl_b32 s36, s41, 17
  s_lshl_b32 s37, s42, 7
  s_add_u32 s36, s36, s37
  v_lshlrev_b32 v32, 11, v4
  v_lshl_add_u32 v32, v5, 4, v32
  v_add_u32 v32, s36, v32
  v_lshlrev_b32 v9, 5, v5
  v_lshl_add_u32 v9, v4, 2, v9
  v_add_u32 v9, 155648, v9
  v_lshlrev_b32 v10, 5, v4
  v_add_u32 v10, 155648, v10
  v_add_u32 v33, 16384, v32
  v_add_u32 v34, 32768, v32
  v_add_u32 v35, 49152, v32
  v_add_u32 v36, 65536, v32
  v_add_u32 v37, 81920, v32
  v_add_u32 v38, 98304, v32
  v_add_u32 v39, 114688, v32
  v_mov_b32 v56, 131072
L_pw_g:
  ds_read_b32 v57, v56
  s_waitcnt lgkmcnt(0)
  v_readfirstlane_b32 s51, v57
  s_cmp_ge_i32 s51, 114
  s_cbranch_scc1 L_pg_g
  s_sub_u32 s34, s34, 1
  s_cbranch_scc1 L_exit
  s_sleep 8
  s_branch L_pw_g
L_pg_g:
  s_mov_b32 s50, 0x3fb8aa3b
L_mw:
  global_load_dwordx2 v[40:41], v8, s[26:27] sc1
  s_waitcnt vmcnt(0)
  v_max_u32 v44, v40, v41
  v_cmp_eq_u32 vcc, -1, v44
  s_cmp_eq_u64 vcc, 0
  s_cbranch_scc1 L_mok
  s_mov_b64 exec, vcc
  s_sub_u32 s34, s34, 1
  s_cbranch_scc1 L_exit
  s_sleep 8
  s_branch L_mw
L_mok:
  s_mov_b64 exec, -1
  s_nop 1
  v_max_f32_dpp v44, v40, v40 quad_perm:[1,0,3,2] row_mask:0xf bank_mask:0xf
  v_sub_f32 v44, v40, v44
  v_mul_f32 v44, s50, v44
  v_exp_f32 v44, v44
  s_nop 0
  v_mul_f32 v44, v44, v41
  s_nop 1
  v_add_f32_dpp v46, v44, v44 quad_perm:[1,0,3,2] row_mask:0xf bank_mask:0xf
  v_rcp_f32 v46, v46
  s_nop 0
  v_mul_f32 v44, v44, v46
  ds_write_b32 v9, v44
  ds_read_b128 v[48:51], v10
  ds_read_b128 v[52:55], v10 offset:16
  s_waitcnt lgkmcnt(0)
  s_barrier
  global_load_dwordx4 v[64:67], v32, s[26:27] sc1
  global_load_dwordx4 v[68:71], v33, s[26:27] sc1
  global_load_dwordx4 v[72:75], v34, s[26:27] sc1
  global_load_dwordx4 v[76:79], v35, s[26:27] sc1
  global_load_dwordx4 v[80:83], v36, s[26:27] sc1
  global_load_dwordx4 v[84:87], v37, s[26:27] sc1
  global_load_dwordx4 v[88:91], v38, s[26:27] sc1
  global_load_dwordx4 v[92:95], v39, s[26:27] sc1
  s_sleep 8
L_yw:
  global_load_dwordx4 v[64:67], v32, s[26:27] sc1
  global_load_dwordx4 v[68:71], v33, s[26:27] sc1
  global_load_dwordx4 v[72:75], v34, s[26:27] sc1
  global_load_dwordx4 v[76:79], v35, s[26:27] sc1
  global_load_dwordx4 v[80:83], v36, s[26:27] sc1
  global_load_dwordx4 v[84:87], v37, s[26:27] sc1
  global_load_dwordx4 v[88:91], v38, s[26:27] sc1
  global_load_dwordx4 v[92:95], v39, s[26:27] sc1
  s_waitcnt vmcnt(8) lgkmcnt(0)
  v_max3_u32 v44, v64, v65, v66
  v_max3_u32 v45, v67, v68, v69
  v_max3_u32 v44, v44, v70, v71
  v_max3_u32 v45, v45, v72, v73
  v_max3_u32 v44, v44, v74, v75
  v_max3_u32 v45, v45, v76, v77
  v_max3_u32 v44, v44, v78, v79
  v_max3_u32 v45, v45, v80, v81
  v_max3_u32 v44, v44, v82, v83
  v_max3_u32 v45, v45, v84, v85
  v_max3_u32 v44, v44, v86, v87
  v_max3_u32 v45, v45, v88, v89
  v_max3_u32 v44, v44, v90, v91
  v_max3_u32 v45, v45, v92, v93
  v_max3_u32 v44, v44, v94, v95
  v_max_u32 v44, v44, v45
  v_cmp_eq_u32 vcc, -1, v44
  s_cmp_eq_u64 vcc, 0
  s_cbranch_scc1 L_yok
  s_mov_b64 exec, vcc
L_ynb:
  s_sub_u32 s34, s34, 1
  s_cbranch_scc1 L_exit
  s_branch L_yw
L_yok:
  s_mov_b64 exec, -1
  v_mul_f32 v40, v64, v48
  v_mul_f32 v41, v65, v48
  v_mul_f32 v42, v66, v48
  v_mul_f32 v43, v67, v48
  v_fmac_f32 v40, v68, v49
  v_fmac_f32 v41, v69, v49
  v_fmac_f32 v42, v70, v49
  v_fmac_f32 v43, v71, v49
  v_fmac_f32 v40, v72, v50
  v_fmac_f32 v41, v73, v50
  v_fmac_f32 v42, v74, v50
  v_fmac_f32 v43, v75, v50
  v_fmac_f32 v40, v76, v51
  v_fmac_f32 v41, v77, v51
  v_fmac_f32 v42, v78, v51
  v_fmac_f32 v43, v79, v51
  v_fmac_f32 v40, v80, v52
  v_fmac_f32 v41, v81, v52
  v_fmac_f32 v42, v82, v52
  v_fmac_f32 v43, v83, v52
  v_fmac_f32 v40, v84, v53
  v_fmac_f32 v41, v85, v53
  v_fmac_f32 v42, v86, v53
  v_fmac_f32 v43, v87, v53
  v_fmac_f32 v40, v88, v54
  v_fmac_f32 v41, v89, v54
  v_fmac_f32 v42, v90, v54
  v_fmac_f32 v43, v91, v54
  v_fmac_f32 v40, v92, v55
  v_fmac_f32 v41, v93, v55
  v_fmac_f32 v42, v94, v55
  v_fmac_f32 v43, v95, v55
  s_nop 1
  v_add_f32_dpp v40, v40, v40 row_ror:8 row_mask:0xf bank_mask:0xf
  v_add_f32_dpp v41, v41, v41 row_ror:8 row_mask:0xf bank_mask:0xf
  v_add_f32_dpp v42, v42, v42 row_ror:8 row_mask:0xf bank_mask:0xf
  v_add_f32_dpp v43, v43, v43 row_ror:8 row_mask:0xf bank_mask:0xf
  v_mov_b32 v44, v40
  v_mov_b32 v45, v41
  v_mov_b32 v46, v42
  v_mov_b32 v47, v43
  s_nop 1
  v_permlane16_swap_b32 v40, v44
  v_permlane16_swap_b32 v41, v45
  v_permlane16_swap_b32 v42, v46
  v_permlane16_swap_b32 v43, v47
  s_nop 1
  v_add_f32 v40, v40, v44
  v_add_f32 v41, v41, v45
  v_add_f32 v42, v42, v46
  v_add_f32 v43, v43, v47
  v_mov_b32 v44, v40
  v_mov_b32 v45, v41
  v_mov_b32 v46, v42
  v_mov_b32 v47, v43
  s_nop 1
  v_permlane32_swap_b32 v40, v44
  v_permlane32_swap_b32 v41, v45
  v_permlane32_swap_b32 v42, v46
  v_permlane32_swap_b32 v43, v47
  s_nop 1
  v_add_f32 v40, v40, v44
  v_add_f32 v41, v41, v45
  v_add_f32 v42, v42, v46
  v_add_f32 v43, v43, v47
  v_cvt_pk_bf16_f32 v40, v40, v40
  v_and_b32 v40, 0xffff0000, v40
  v_cvt_pk_bf16_f32 v41, v41, v41
  v_and_b32 v41, 0xffff0000, v41
  v_cvt_pk_bf16_f32 v42, v42, v42
  v_and_b32 v42, 0xffff0000, v42
  v_cvt_pk_bf16_f32 v43, v43, v43
  v_and_b32 v43, 0xffff0000, v43
  v_mul_f32 v40, v40, v16
  v_mul_f32 v41, v41, v17
  v_mul_f32 v42, v42, v18
  v_mul_f32 v43, v43, v19
  v_cvt_pk_bf16_f32 v40, v40, v40
  v_and_b32 v40, 0xffff0000, v40
  v_cvt_pk_bf16_f32 v41, v41, v41
  v_and_b32 v41, 0xffff0000, v41
  v_cvt_pk_bf16_f32 v42, v42, v42
  v_and_b32 v42, 0xffff0000, v42
  v_cvt_pk_bf16_f32 v43, v43, v43
  v_and_b32 v43, 0xffff0000, v43
  v_add_f32 v40, v40, v26
  v_add_f32 v41, v41, v27
  v_add_f32 v42, v42, v28
  v_add_f32 v43, v43, v29
  v_cvt_pk_bf16_f32 v40, v40, v41
  v_cvt_pk_bf16_f32 v41, v42, v43
  s_mov_b64 exec, 0xff
  global_store_dwordx2 v61, v[40:41], s[22:23]
  s_mov_b64 exec, -1
L_exit:
  s_endpgm
L_codeend:
  .section .rodata,"a"
  .p2align 6
  .amdhsa_kernel recurrent_scan__mha_block_cached__swiglu_ffn__decode_kernel
  .amdhsa_next_free_vgpr 256
  .amdhsa_next_free_sgpr 64
  .amdhsa_accum_offset 256
  .amdhsa_group_segment_fixed_size 0
  .amdhsa_kernarg_size 96
  .amdhsa_user_sgpr_count 2
  .amdhsa_user_sgpr_kernarg_segment_ptr 1
  .amdhsa_system_sgpr_workgroup_id_x 1
  .amdhsa_float_denorm_mode_32 3
  .end_amdhsa_kernel
```
